```python
import torch

def _softmax(x, axis=-1):
    return torch.softmax(x, dim=axis)
def _gelu(x):
    return torch.nn.functional.gelu(x, approximate="tanh")
def _silu(x):
    return torch.nn.functional.silu(x)
def _sigmoid(x):
    return torch.sigmoid(x)
def _layernorm(x, axis=-1, eps=1e-5):
    m = x.mean(dim=axis, keepdim=True)
    v = x.var(dim=axis, keepdim=True, unbiased=False)
    return (x - m) / torch.sqrt(v + eps)
def _scatter_add(tgt, idx, src, axis=0):
    return tgt.clone().index_add_(axis, idx, src)
def _segment_sum(src, seg, n):
    out = torch.zeros((n,) + src.shape[1:], dtype=src.dtype)
    return out.index_add_(0, seg, src)
def _pad(x, pw):
    flat = tuple(v for pair in reversed(pw) for v in pair)
    return torch.nn.functional.pad(x, flat)

kernel_name = 'gated_mix__sliding_local_dilated__grouped_kv_mqa__prompt'

def setup_inputs():

    _w = (lambda a: (lambda t: t.to(torch.bfloat16) if t.is_floating_point() else t)(torch.as_tensor(a)))
    def _A_setup():
        B, S, D = 1, 2048, 512
        return {
            "x": _w((lambda *s: torch.randn(*s, dtype=torch.bfloat16) * 0.05)(B, S, D)),
            "wqkv": _w((lambda *s: torch.randn(*s, dtype=torch.bfloat16) * 0.8)(D, 3 * D)),
            "wo": _w((lambda *s: torch.randn(*s, dtype=torch.bfloat16) * 0.05)(D, D)),
        }
    _A_in = _A_setup()

    def _B_setup():
        B, S, D, H = 1, 2048, 512, 32
        Dh = D // H
        return {
            "x": _w((lambda *s: torch.randn(*s, dtype=torch.bfloat16) * 0.05)(B, S, D)),
            "wq": _w((lambda *s: torch.randn(*s, dtype=torch.bfloat16) * 1.6)(D, H * Dh)),
            "wk": _w((lambda *s: torch.randn(*s, dtype=torch.bfloat16) * 1.6)(D, Dh)),
            "wv": _w((lambda *s: torch.randn(*s, dtype=torch.bfloat16) * 0.2)(D, Dh)),
            "wo": _w((lambda *s: torch.randn(*s, dtype=torch.bfloat16) * 0.2)(H * Dh, D)),
        }
    _B_in = _B_setup()

    return {
        "A_x": _A_in["x"],
        "A_wqkv": _A_in["wqkv"],
        "A_wo": _A_in["wo"],
        "B_x": _B_in["x"],
        "B_wq": _B_in["wq"],
        "B_wk": _B_in["wk"],
        "B_wv": _B_in["wv"],
        "B_wo": _B_in["wo"],
        "gate_w": _w((lambda *s: torch.randn(*s, dtype=torch.bfloat16) * 0.05)(512) * 16.0),
    }

def reference(A_x, A_wqkv, A_wo, B_x, B_wq, B_wk, B_wv, B_wo, gate_w):
    def _A_ref(x, wqkv, wo):
        B, S, D = x.shape
        H = 32; Dh = D // H
        W, dil = 8, 2
        qkv = (lambda x, *d: x.permute(*d))((x @ wqkv).reshape(B, S, 3, H, Dh), 2, 0, 3, 1, 4)
        q, k, v = qkv[0], qkv[1], qkv[2]
        scale = Dh ** -0.5
        pos = torch.arange(S)
        off = torch.arange(W) * dil
        idx = pos[:, None] - off[None, :]
        mask = idx >= 0
        idx_c = torch.where(mask, idx, 0).reshape(-1)
        kg = k[:, :, idx_c, :].reshape(B, H, S, W, Dh)
        vg = v[:, :, idx_c, :].reshape(B, H, S, W, Dh)
        logits = torch.einsum("bhsd,bhswd->bhsw", q, kg) * scale
        logits = torch.where(mask[None, None, :, :], logits, -1e9)
        attn = _softmax(logits, axis=-1)
        o = torch.einsum("bhsw,bhswd->bhsd", attn, vg)
        return (lambda x, *d: x.permute(*d))(o, 0, 2, 1, 3).reshape(B, S, D) @ wo

    def _B_ref(x, wq, wk, wv, wo):
        B, S, D = x.shape
        H = 32
        Dh = D // H
        q = (lambda x, *d: x.permute(*d))((x @ wq).reshape(B, S, H, Dh), 0, 2, 1, 3)
        k = x @ wk
        v = x @ wv
        scores = torch.einsum("bhqd,bkd->bhqk", q, k) * (Dh ** -0.5)
        p = _softmax(scores, axis=-1)
        o = torch.einsum("bhqk,bkd->bhqd", p, v)
        return (lambda x, *d: x.permute(*d))(o, 0, 2, 1, 3).reshape(B, S, H * Dh) @ wo

    x = A_x
    g = _sigmoid((x * gate_w).sum(-1, keepdims=True))
    a = _A_ref(x, A_wqkv, A_wo)
    b = _B_ref(x, B_wq, B_wk, B_wv, B_wo)
    return g * a + (1 - g) * b
```

```asm
; @launch grid=(256,1,1) block=(768,1,1) lds=163840
.amdgcn_target "amdgcn-amd-amdhsa--gfx950"
.text
.globl gated_mix__sliding_local_dilated__grouped_kv_mqa__prompt_kernel
.p2align 8
.type gated_mix__sliding_local_dilated__grouped_kv_mqa__prompt_kernel,@function
gated_mix__sliding_local_dilated__grouped_kv_mqa__prompt_kernel:
    s_cmp_ge_u32 s2, 256
    s_cbranch_scc1 L_end
    s_load_dwordx16 s[64:79], s[0:1], 0
    s_load_dwordx8 s[80:87], s[0:1], 64
    v_and_b32 v1, 63, v0
    v_lshrrev_b32 v2, 6, v0
    s_and_b32 s48, s2, 7
    s_lshr_b32 s49, s2, 3
    v_readfirstlane_b32 s3, v2
    s_lshr_b32 s50, s48, 1
    s_lshl_b32 s50, s50, 3
    s_and_b32 s51, s49, 7
    s_add_u32 s4, s50, s51
    s_and_b32 s50, s48, 1
    s_lshr_b32 s51, s49, 3
    s_lshl_b32 s51, s51, 1
    s_add_u32 s5, s50, s51
    s_lshl_b32 s6, s4, 6
    s_lshl_b32 s88, s4, 3
    s_add_u32 s88, s88, s5
    s_and_b32 s90, s3, 3
    s_and_b32 s7, s5, 3
    s_lshr_b32 s97, s5, 1
    s_add_u32 s97, s97, s4
    s_and_b32 s97, s97, 3
    v_lshlrev_b32 v16, 4, v1
    v_and_b32 v19, 31, v1
    s_and_b32 s94, s49, 7
    s_lshl_b32 s94, s94, 14
    s_mov_b32 s92, 0x0000ffff
    s_mov_b32 s93, 0x0000ffff
    s_add_u32 s48, s97, 0
    s_and_b32 s48, s48, 3
    s_lshl_b32 s52, s48, 8
    s_add_u32 s48, s97, 1
    s_and_b32 s48, s48, 3
    s_lshl_b32 s53, s48, 8
    s_add_u32 s48, s97, 2
    s_and_b32 s48, s48, 3
    s_lshl_b32 s54, s48, 8
    s_add_u32 s48, s97, 3
    s_and_b32 s48, s48, 3
    s_lshl_b32 s55, s48, 8
    v_lshrrev_b32 v10, 4, v1
    v_and_b32 v11, 15, v1
    s_lshl_b32 s48, s90, 2
    v_add_u32 v12, s48, v10
    v_xor_b32 v11, v11, v12
    v_lshlrev_b32 v11, 4, v11
    v_lshlrev_b32 v10, 10, v10
    v_add_u32 v29, v10, v11
    s_sub_u32 s49, s6, 16
    s_max_i32 s50, s49, 0
    s_add_u32 s49, s49, s48
    s_add_u32 s50, s50, s48
    s_lshl_b32 s98, s49, 10
    s_lshl_b32 s99, s50, 10
    s_lshl_b32 s91, s90, 10
    s_lshl_b32 s96, s90, 12
    s_add_u32 s48, s7, 0
    s_and_b32 s48, s48, 3
    s_add_u32 s48, s48, 1
    s_lshl_b32 s49, s48, 12
    s_add_u32 s56, s49, s91
    s_lshl_b32 s49, s48, 14
    s_add_u32 s60, s49, s98
    s_add_u32 s48, s7, 1
    s_and_b32 s48, s48, 3
    s_add_u32 s48, s48, 1
    s_lshl_b32 s49, s48, 12
    s_add_u32 s57, s49, s91
    s_lshl_b32 s49, s48, 14
    s_add_u32 s61, s49, s98
    s_add_u32 s48, s7, 2
    s_and_b32 s48, s48, 3
    s_add_u32 s48, s48, 1
    s_lshl_b32 s49, s48, 12
    s_add_u32 s58, s49, s91
    s_lshl_b32 s49, s48, 14
    s_add_u32 s62, s49, s98
    s_add_u32 s48, s7, 3
    s_and_b32 s48, s48, 3
    s_add_u32 s48, s48, 1
    s_lshl_b32 s49, s48, 12
    s_add_u32 s59, s49, s91
    s_lshl_b32 s49, s48, 14
    s_add_u32 s63, s49, s98
    s_waitcnt lgkmcnt(0)
    s_mov_b32 s8, s64
    s_and_b32 s9, s65, 0xffff
    s_mov_b32 s10, 2097152
    s_mov_b32 s11, 0x00020000
    s_cmp_ge_u32 s5, 4
    s_cselect_b32 s74, s76, s74
    s_cselect_b32 s75, s77, s75
    s_mov_b32 s24, s74
    s_and_b32 s25, s75, 0xffff
    s_mov_b32 s26, 16384
    s_mov_b32 s27, 0x00020000
    s_mov_b32 s44, s72
    s_and_b32 s45, s73, 0xffff
    s_mov_b32 s46, 524288
    s_mov_b32 s47, 0x00020000
    s_mov_b32 s12, s66
    s_and_b32 s13, s67, 0xffff
    s_mov_b32 s14, 1572864
    s_mov_b32 s15, 0x00020000
    s_mov_b32 s16, s86
    s_and_b32 s17, s87, 0xffff
    s_mov_b32 s18, 33554432
    s_mov_b32 s19, 0x00020000
    s_mov_b32 s20, s84
    s_and_b32 s21, s85, 0xffff
    s_mov_b32 s22, 256
    s_mov_b32 s23, 0x00020000
    s_mov_b32 s28, s80
    s_and_b32 s29, s81, 0xffff
    s_mov_b32 s30, 1024
    s_mov_b32 s31, 0x00020000
    s_mov_b32 s32, s68
    s_and_b32 s33, s69, 0xffff
    s_mov_b32 s34, 524288
    s_mov_b32 s35, 0x00020000
    s_mov_b32 s36, s78
    s_and_b32 s37, s79, 0xffff
    s_mov_b32 s38, 524288
    s_mov_b32 s39, 0x00020000
    s_mov_b32 s40, s82
    s_and_b32 s41, s83, 0xffff
    s_mov_b32 s42, 2097152
    s_mov_b32 s43, 0x00020000
    s_cmp_ge_u32 s3, 8
    s_cbranch_scc1 L_sw
    s_cmp_ge_u32 s3, 4
    s_cbranch_scc1 L_g_nogate
    s_cmp_lt_u32 s5, 4
    s_cbranch_scc1 L_g_nogate
    v_lshrrev_b32 v7, 4, v1
    v_lshlrev_b32 v7, 4, v7
    s_add_u32 s50, s3, s97
    s_and_b32 s50, s50, 3
    s_lshl_b32 s50, s50, 8
    s_mov_b32 s48, 0x00010001
    s_mov_b32 s49, 0x00010001
    s_mov_b64 exec, s[48:49]
    buffer_load_dwordx4 v[80:83], v7, s[28:31], s50 offen offset:0
    buffer_load_dwordx4 v[84:87], v7, s[28:31], s50 offen offset:64
    buffer_load_dwordx4 v[88:91], v7, s[28:31], s50 offen offset:128
    buffer_load_dwordx4 v[92:95], v7, s[28:31], s50 offen offset:192
    s_mov_b64 exec, -1
L_g_nogate:
    v_lshrrev_b32 v8, 5, v1
    v_lshlrev_b32 v9, 4, v19
    v_lshlrev_b32 v8, 8, v8
    v_add_u32 v9, v9, v8
    v_add_u32 v18, 8192, v9
    v_add_u32 v17, 0, v16
    v_and_b32 v8, 3, v1
    v_lshlrev_b32 v8, 11, v8
    v_bfe_u32 v9, v1, 2, 3
    s_lshl_b32 s48, s3, 3
    s_and_b32 s49, s48, 31
    v_add_u32 v9, s49, v9
    v_and_b32 v10, 32, v1
    v_add_u32 v9, v9, v10
    v_lshlrev_b32 v9, 4, v9
    s_lshr_b32 s73, s3, 2
    s_lshl_b32 s49, s73, 10
    s_add_u32 s49, s49, 147456
    v_add3_u32 v30, v8, v9, s49
    v_lshrrev_b32 v11, 5, v1
    v_and_b32 v13, 15, v19
    v_xor_b32 v13, v13, v11
    v_lshlrev_b32 v13, 4, v13
    v_add_u32 v12, 16, v19
    v_lshlrev_b32 v12, 8, v12
    s_and_b32 s75, s3, 1
    s_lshr_b32 s74, s3, 1
    s_add_u32 s74, s74, 1
    s_cmp_eq_u32 s74, 3
    s_cselect_b32 s74, 0, s74
    s_cmp_eq_u32 s74, 4
    s_cselect_b32 s74, 3, s74
    s_lshl_b32 s48, s75, 13
    v_add3_u32 v20, v12, v13, s48
    v_xor_b32 v21, 32, v20
    v_xor_b32 v22, 64, v20
    v_xor_b32 v23, 96, v20
    v_xor_b32 v24, 128, v20
    v_xor_b32 v25, 160, v20
    v_xor_b32 v26, 192, v20
    v_xor_b32 v27, 224, v20
    v_lshrrev_b32 v10, 4, v1
    v_and_b32 v11, 1, v10
    v_lshrrev_b32 v10, 1, v10
    v_bfe_u32 v12, v1, 2, 2
    v_and_b32 v13, 3, v1
    v_lshlrev_b32 v14, 3, v10
    v_add_u32 v14, v14, v12
    v_lshlrev_b32 v14, 7, v14
    v_lshrrev_b32 v15, 1, v12
    v_lshlrev_b32 v15, 6, v15
    v_lshlrev_b32 v11, 5, v11
    v_lshlrev_b32 v13, 3, v13
    v_add3_u32 v14, v14, v15, v11
    v_add_u32 v14, v14, v13
    s_lshl_b32 s48, s74, 12
    s_add_u32 s48, s48, 81920
    v_add_u32 v6, s48, v14
    v_xor_b32 v7, 64, v6
    s_lshl_b32 s48, s74, 2
    s_lshl_b32 s49, s75, 1
    s_add_u32 s48, s48, s49
    s_mul_i32 s48, s48, 2560
    s_add_u32 s48, s48, 98304
    v_lshrrev_b32 v12, 5, v1
    v_lshlrev_b32 v13, 5, v19
    v_lshlrev_b32 v12, 4, v12
    v_add3_u32 v31, v13, v12, s48
    s_mul_i32 s49, s74, 10240
    s_add_u32 s49, s49, 98816
    v_add3_u32 v160, v13, v12, s49
    v_add_u32 v161, 147456, v16
    s_movk_i32 s50, 2560
    s_cmp_eq_u32 s74, 3
    s_cselect_b64 vcc, -1, 0
    s_cselect_b32 s50, 2048, s50
    v_cndmask_b32 v160, v160, v161, vcc
    s_lshl_b32 s48, s75, 10
    v_add_u32 v160, s48, v160
    v_add_u32 v161, s50, v160
    v_add_u32 v162, s50, v161
    v_add_u32 v163, s50, v162
    v_and_b32 v164, 16, v1
    v_lshlrev_b32 v164, 8, v164
    s_lshl_b32 s48, s75, 13
    s_add_u32 s48, s48, 4096
    v_add_u32 v164, s48, v164
    s_cmp_eq_u32 s75, 1
    s_cselect_b64 vcc, -1, 0
    v_cndmask_b32 v28, v6, v7, vcc
    v_cndmask_b32 v7, v7, v6, vcc
    v_mov_b32 v6, v28
    v_cndmask_b32 v28, v160, v162, vcc
    v_cndmask_b32 v162, v162, v160, vcc
    v_mov_b32 v160, v28
    v_cndmask_b32 v28, v161, v163, vcc
    v_cndmask_b32 v163, v163, v161, vcc
    v_mov_b32 v161, v28
    s_cmp_ge_u32 s3, 4
    s_cbranch_scc1 L_kv_skip
    s_lshl_b32 s48, s7, 4
    s_add_u32 s48, s48, 16
    v_and_b32 v12, 15, v1
    v_lshrrev_b32 v13, 4, v1
    v_add_u32 v14, s48, v12
    v_lshlrev_b32 v14, 8, v14
    v_xor_b32 v15, v12, v13
    v_lshlrev_b32 v15, 4, v15
    s_mul_i32 s49, s3, 20480
    v_add3_u32 v2, v15, v14, s49
    v_xor_b32 v3, 64, v2
    v_xor_b32 v4, 128, v2
    v_xor_b32 v5, 192, v2
    v_bfe_u32 v14, v1, 2, 2
    v_lshlrev_b32 v15, 3, v13
    v_add_u32 v15, v15, v14
    v_lshlrev_b32 v15, 5, v15
    v_and_b32 v14, 3, v1
    v_lshlrev_b32 v14, 3, v14
    s_add_u32 s49, s3, s97
    s_and_b32 s49, s49, 3
    s_lshl_b32 s49, s49, 12
    s_add_u32 s49, s49, 147456
    v_add3_u32 v8, v15, v14, s49
    s_lshl_b32 s49, s3, 10
    s_add_u32 s49, s49, 61440
    v_add_u32 v9, s49, v16
    v_lshlrev_b32 v10, 2, v1
    s_lshl_b32 s49, s3, 8
    s_add_u32 s49, s49, 40960
    v_add_u32 v10, s49, v10
    s_waitcnt vmcnt(0)
    s_barrier
    ds_read_b128 v[128:131], v2
    ds_read_b64_tr_b16 v[32:33], v8 offset:0
    ds_read_b64_tr_b16 v[34:35], v8 offset:128
    ds_read_b128 v[132:135], v3
    ds_read_b64_tr_b16 v[36:37], v8 offset:1024
    ds_read_b64_tr_b16 v[38:39], v8 offset:1152
    ds_read_b128 v[136:139], v4
    ds_read_b64_tr_b16 v[40:41], v8 offset:2048
    ds_read_b64_tr_b16 v[42:43], v8 offset:2176
    ds_read_b128 v[140:143], v5
    ds_read_b64_tr_b16 v[44:45], v8 offset:3072
    ds_read_b64_tr_b16 v[46:47], v8 offset:3200
    s_cmp_ge_u32 s5, 4
    s_cbranch_scc1 L_kv_V
    s_waitcnt lgkmcnt(9)
    v_mfma_f32_16x16x32_bf16 v[64:67], v[32:35], v[128:131], 0
    s_waitcnt lgkmcnt(6)
    v_mfma_f32_16x16x32_bf16 v[64:67], v[36:39], v[132:135], v[64:67]
    s_waitcnt lgkmcnt(3)
    v_mfma_f32_16x16x32_bf16 v[64:67], v[40:43], v[136:139], v[64:67]
    s_waitcnt lgkmcnt(0)
    v_mfma_f32_16x16x32_bf16 v[64:67], v[44:47], v[140:143], v[64:67]
    s_branch L_kv_done
L_kv_V:
    s_waitcnt lgkmcnt(9)
    v_mfma_f32_16x16x32_bf16 v[68:71], v[80:83], v[128:131], 0
    s_nop 2
    v_mfma_f32_16x16x32_bf16 v[64:67], v[128:131], v[32:35], 0
    s_waitcnt lgkmcnt(6)
    v_mfma_f32_16x16x32_bf16 v[68:71], v[84:87], v[132:135], v[68:71]
    v_mfma_f32_16x16x32_bf16 v[64:67], v[132:135], v[36:39], v[64:67]
    s_waitcnt lgkmcnt(3)
    v_mfma_f32_16x16x32_bf16 v[68:71], v[88:91], v[136:139], v[68:71]
    v_mfma_f32_16x16x32_bf16 v[64:67], v[136:139], v[40:43], v[64:67]
    s_waitcnt lgkmcnt(0)
    v_mfma_f32_16x16x32_bf16 v[68:71], v[92:95], v[140:143], v[68:71]
    v_mfma_f32_16x16x32_bf16 v[64:67], v[140:143], v[44:47], v[64:67]
    s_nop 6
    ds_write_b32 v10, v68
L_kv_done:
    s_nop 7
    ds_write_b128 v9, v[64:67]
    s_waitcnt lgkmcnt(0)
    s_barrier
    ds_read_b64_tr_b16 v[128:129], v6 offset:0
    ds_read_b64_tr_b16 v[130:131], v6 offset:512
    ds_read_b64_tr_b16 v[136:137], v7 offset:0
    ds_read_b64_tr_b16 v[138:139], v7 offset:512
    ds_read_b128 v[96:99], v20 offset:0
    ds_read_b64_tr_b16 v[132:133], v6 offset:2048
    ds_read_b64_tr_b16 v[134:135], v6 offset:2560
    ds_read_b64_tr_b16 v[140:141], v7 offset:2048
    ds_read_b64_tr_b16 v[142:143], v7 offset:2560
    ds_read_b128 v[100:103], v21 offset:0
    v_sub_u32 v4, v20, v164
    ds_read_b128 v[112:115], v4 offset:0
    v_sub_u32 v5, v21, v164
    ds_read_b128 v[116:119], v5 offset:0
    s_waitcnt lgkmcnt(0)
    s_barrier
    v_mfma_f32_32x32x16_bf16 v[64:79], v[128:131], v[96:99], 0
    ds_read_b64_tr_b16 v[144:145], v6 offset:16384
    ds_read_b64_tr_b16 v[146:147], v6 offset:16896
    ds_read_b64_tr_b16 v[152:153], v7 offset:16384
    ds_read_b64_tr_b16 v[154:155], v7 offset:16896
    v_mfma_f32_32x32x16_bf16 v[80:95], v[136:139], v[96:99], 0
    ds_read_b128 v[104:107], v22 offset:0
    ds_read_b64_tr_b16 v[148:149], v6 offset:18432
    ds_read_b64_tr_b16 v[150:151], v6 offset:18944
    ds_read_b64_tr_b16 v[156:157], v7 offset:18432
    v_mfma_f32_32x32x16_bf16 v[32:47], v[128:131], v[112:115], 0
    ds_read_b64_tr_b16 v[158:159], v7 offset:18944
    ds_read_b128 v[108:111], v23 offset:0
    v_sub_u32 v4, v22, v164
    ds_read_b128 v[120:123], v4 offset:0
    v_mfma_f32_32x32x16_bf16 v[64:79], v[132:135], v[100:103], v[64:79]
    v_sub_u32 v5, v23, v164
    ds_read_b128 v[124:127], v5 offset:0
    v_mfma_f32_32x32x16_bf16 v[80:95], v[140:143], v[100:103], v[80:95]
    v_mfma_f32_32x32x16_bf16 v[32:47], v[132:135], v[116:119], v[32:47]
    s_waitcnt lgkmcnt(0)
    s_barrier
    v_mfma_f32_32x32x16_bf16 v[64:79], v[144:147], v[104:107], v[64:79]
    ds_read_b64_tr_b16 v[128:129], v6 offset:32768
    ds_read_b64_tr_b16 v[130:131], v6 offset:33280
    ds_read_b64_tr_b16 v[136:137], v7 offset:32768
    ds_read_b64_tr_b16 v[138:139], v7 offset:33280
    v_mfma_f32_32x32x16_bf16 v[80:95], v[152:155], v[104:107], v[80:95]
    ds_read_b128 v[96:99], v24 offset:0
    ds_read_b64_tr_b16 v[132:133], v6 offset:34816
    ds_read_b64_tr_b16 v[134:135], v6 offset:35328
    ds_read_b64_tr_b16 v[140:141], v7 offset:34816
    v_mfma_f32_32x32x16_bf16 v[32:47], v[144:147], v[120:123], v[32:47]
    ds_read_b64_tr_b16 v[142:143], v7 offset:35328
    ds_read_b128 v[100:103], v25 offset:0
    v_sub_u32 v4, v24, v164
    ds_read_b128 v[112:115], v4 offset:0
    v_mfma_f32_32x32x16_bf16 v[64:79], v[148:151], v[108:111], v[64:79]
    v_sub_u32 v5, v25, v164
    ds_read_b128 v[116:119], v5 offset:0
    v_mfma_f32_32x32x16_bf16 v[80:95], v[156:159], v[108:111], v[80:95]
    v_mfma_f32_32x32x16_bf16 v[32:47], v[148:151], v[124:127], v[32:47]
    s_waitcnt lgkmcnt(0)
    s_barrier
    v_mfma_f32_32x32x16_bf16 v[64:79], v[128:131], v[96:99], v[64:79]
    ds_read_b64_tr_b16 v[144:145], v6 offset:49152
    ds_read_b64_tr_b16 v[146:147], v6 offset:49664
    ds_read_b64_tr_b16 v[152:153], v7 offset:49152
    ds_read_b64_tr_b16 v[154:155], v7 offset:49664
    v_mfma_f32_32x32x16_bf16 v[80:95], v[136:139], v[96:99], v[80:95]
    ds_read_b128 v[104:107], v26 offset:0
    ds_read_b64_tr_b16 v[148:149], v6 offset:51200
    ds_read_b64_tr_b16 v[150:151], v6 offset:51712
    ds_read_b64_tr_b16 v[156:157], v7 offset:51200
    v_mfma_f32_32x32x16_bf16 v[32:47], v[128:131], v[112:115], v[32:47]
    ds_read_b64_tr_b16 v[158:159], v7 offset:51712
    ds_read_b128 v[108:111], v27 offset:0
    v_sub_u32 v4, v26, v164
    ds_read_b128 v[120:123], v4 offset:0
    v_mfma_f32_32x32x16_bf16 v[64:79], v[132:135], v[100:103], v[64:79]
    v_sub_u32 v5, v27, v164
    ds_read_b128 v[124:127], v5 offset:0
    v_mfma_f32_32x32x16_bf16 v[80:95], v[140:143], v[100:103], v[80:95]
    v_mfma_f32_32x32x16_bf16 v[32:47], v[132:135], v[116:119], v[32:47]
    s_waitcnt lgkmcnt(0)
    s_barrier
    v_mfma_f32_32x32x16_bf16 v[64:79], v[144:147], v[104:107], v[64:79]
    ds_read_b64_tr_b16 v[128:129], v6 offset:0
    ds_read_b64_tr_b16 v[130:131], v6 offset:512
    ds_read_b64_tr_b16 v[136:137], v7 offset:0
    ds_read_b64_tr_b16 v[138:139], v7 offset:512
    v_mfma_f32_32x32x16_bf16 v[80:95], v[152:155], v[104:107], v[80:95]
    ds_read_b128 v[96:99], v20 offset:20480
    ds_read_b64_tr_b16 v[132:133], v6 offset:2048
    ds_read_b64_tr_b16 v[134:135], v6 offset:2560
    ds_read_b64_tr_b16 v[140:141], v7 offset:2048
    v_mfma_f32_32x32x16_bf16 v[32:47], v[144:147], v[120:123], v[32:47]
    ds_read_b64_tr_b16 v[142:143], v7 offset:2560
    ds_read_b128 v[100:103], v21 offset:20480
    v_sub_u32 v4, v20, v164
    ds_read_b128 v[112:115], v4 offset:20480
    v_mfma_f32_32x32x16_bf16 v[64:79], v[148:151], v[108:111], v[64:79]
    v_sub_u32 v5, v21, v164
    ds_read_b128 v[116:119], v5 offset:20480
    v_mfma_f32_32x32x16_bf16 v[80:95], v[156:159], v[108:111], v[80:95]
    v_mfma_f32_32x32x16_bf16 v[32:47], v[148:151], v[124:127], v[32:47]
    s_waitcnt lgkmcnt(0)
    s_barrier
    v_mfma_f32_32x32x16_bf16 v[64:79], v[128:131], v[96:99], v[64:79]
    ds_read_b64_tr_b16 v[144:145], v6 offset:16384
    ds_read_b64_tr_b16 v[146:147], v6 offset:16896
    ds_read_b64_tr_b16 v[152:153], v7 offset:16384
    ds_read_b64_tr_b16 v[154:155], v7 offset:16896
    v_mfma_f32_32x32x16_bf16 v[80:95], v[136:139], v[96:99], v[80:95]
    ds_read_b128 v[104:107], v22 offset:20480
    ds_read_b64_tr_b16 v[148:149], v6 offset:18432
    ds_read_b64_tr_b16 v[150:151], v6 offset:18944
    ds_read_b64_tr_b16 v[156:157], v7 offset:18432
    v_mfma_f32_32x32x16_bf16 v[32:47], v[128:131], v[112:115], v[32:47]
    ds_read_b64_tr_b16 v[158:159], v7 offset:18944
    ds_read_b128 v[108:111], v23 offset:20480
    v_sub_u32 v4, v22, v164
    ds_read_b128 v[120:123], v4 offset:20480
    v_mfma_f32_32x32x16_bf16 v[64:79], v[132:135], v[100:103], v[64:79]
    v_sub_u32 v5, v23, v164
    ds_read_b128 v[124:127], v5 offset:20480
    v_mfma_f32_32x32x16_bf16 v[80:95], v[140:143], v[100:103], v[80:95]
    v_mfma_f32_32x32x16_bf16 v[32:47], v[132:135], v[116:119], v[32:47]
    s_waitcnt lgkmcnt(0)
    s_barrier
    v_mfma_f32_32x32x16_bf16 v[64:79], v[144:147], v[104:107], v[64:79]
    ds_read_b64_tr_b16 v[128:129], v6 offset:32768
    ds_read_b64_tr_b16 v[130:131], v6 offset:33280
    ds_read_b64_tr_b16 v[136:137], v7 offset:32768
    ds_read_b64_tr_b16 v[138:139], v7 offset:33280
    v_mfma_f32_32x32x16_bf16 v[80:95], v[152:155], v[104:107], v[80:95]
    ds_read_b128 v[96:99], v24 offset:20480
    ds_read_b64_tr_b16 v[132:133], v6 offset:34816
    ds_read_b64_tr_b16 v[134:135], v6 offset:35328
    ds_read_b64_tr_b16 v[140:141], v7 offset:34816
    v_mfma_f32_32x32x16_bf16 v[32:47], v[144:147], v[120:123], v[32:47]
    ds_read_b64_tr_b16 v[142:143], v7 offset:35328
    ds_read_b128 v[100:103], v25 offset:20480
    v_sub_u32 v4, v24, v164
    ds_read_b128 v[112:115], v4 offset:20480
    v_mfma_f32_32x32x16_bf16 v[64:79], v[148:151], v[108:111], v[64:79]
    v_sub_u32 v5, v25, v164
    ds_read_b128 v[116:119], v5 offset:20480
    v_mfma_f32_32x32x16_bf16 v[80:95], v[156:159], v[108:111], v[80:95]
    v_mfma_f32_32x32x16_bf16 v[32:47], v[148:151], v[124:127], v[32:47]
    s_waitcnt lgkmcnt(0)
    s_barrier
    v_mfma_f32_32x32x16_bf16 v[64:79], v[128:131], v[96:99], v[64:79]
    ds_read_b64_tr_b16 v[144:145], v6 offset:49152
    ds_read_b64_tr_b16 v[146:147], v6 offset:49664
    ds_read_b64_tr_b16 v[152:153], v7 offset:49152
    ds_read_b64_tr_b16 v[154:155], v7 offset:49664
    v_mfma_f32_32x32x16_bf16 v[80:95], v[136:139], v[96:99], v[80:95]
    ds_read_b128 v[104:107], v26 offset:20480
    ds_read_b64_tr_b16 v[148:149], v6 offset:51200
    ds_read_b64_tr_b16 v[150:151], v6 offset:51712
    ds_read_b64_tr_b16 v[156:157], v7 offset:51200
    v_mfma_f32_32x32x16_bf16 v[32:47], v[128:131], v[112:115], v[32:47]
    ds_read_b64_tr_b16 v[158:159], v7 offset:51712
    ds_read_b128 v[108:111], v27 offset:20480
    v_sub_u32 v4, v26, v164
    ds_read_b128 v[120:123], v4 offset:20480
    v_mfma_f32_32x32x16_bf16 v[64:79], v[132:135], v[100:103], v[64:79]
    v_sub_u32 v5, v27, v164
    ds_read_b128 v[124:127], v5 offset:20480
    v_mfma_f32_32x32x16_bf16 v[80:95], v[140:143], v[100:103], v[80:95]
    v_mfma_f32_32x32x16_bf16 v[32:47], v[132:135], v[116:119], v[32:47]
    s_waitcnt lgkmcnt(0)
    s_barrier
    v_add_u32 v20, 40960, v20
    v_add_u32 v21, 40960, v21
    v_add_u32 v22, 40960, v22
    v_add_u32 v23, 40960, v23
    v_add_u32 v24, 40960, v24
    v_add_u32 v25, 40960, v25
    v_add_u32 v26, 40960, v26
    v_add_u32 v27, 40960, v27
    v_mfma_f32_32x32x16_bf16 v[64:79], v[144:147], v[104:107], v[64:79]
    ds_read_b64_tr_b16 v[128:129], v6 offset:0
    ds_read_b64_tr_b16 v[130:131], v6 offset:512
    ds_read_b64_tr_b16 v[136:137], v7 offset:0
    ds_read_b64_tr_b16 v[138:139], v7 offset:512
    v_mfma_f32_32x32x16_bf16 v[80:95], v[152:155], v[104:107], v[80:95]
    ds_read_b128 v[96:99], v20 offset:0
    ds_read_b64_tr_b16 v[132:133], v6 offset:2048
    ds_read_b64_tr_b16 v[134:135], v6 offset:2560
    ds_read_b64_tr_b16 v[140:141], v7 offset:2048
    v_mfma_f32_32x32x16_bf16 v[32:47], v[144:147], v[120:123], v[32:47]
    ds_read_b64_tr_b16 v[142:143], v7 offset:2560
    ds_read_b128 v[100:103], v21 offset:0
    v_sub_u32 v4, v20, v164
    ds_read_b128 v[112:115], v4 offset:0
    v_mfma_f32_32x32x16_bf16 v[64:79], v[148:151], v[108:111], v[64:79]
    v_sub_u32 v5, v21, v164
    ds_read_b128 v[116:119], v5 offset:0
    v_mfma_f32_32x32x16_bf16 v[80:95], v[156:159], v[108:111], v[80:95]
    v_mfma_f32_32x32x16_bf16 v[32:47], v[148:151], v[124:127], v[32:47]
    s_waitcnt lgkmcnt(0)
    s_barrier
    v_mfma_f32_32x32x16_bf16 v[64:79], v[128:131], v[96:99], v[64:79]
    ds_read_b64_tr_b16 v[144:145], v6 offset:16384
    ds_read_b64_tr_b16 v[146:147], v6 offset:16896
    ds_read_b64_tr_b16 v[152:153], v7 offset:16384
    ds_read_b64_tr_b16 v[154:155], v7 offset:16896
    v_mfma_f32_32x32x16_bf16 v[80:95], v[136:139], v[96:99], v[80:95]
    ds_read_b128 v[104:107], v22 offset:0
    ds_read_b64_tr_b16 v[148:149], v6 offset:18432
    ds_read_b64_tr_b16 v[150:151], v6 offset:18944
    ds_read_b64_tr_b16 v[156:157], v7 offset:18432
    v_mfma_f32_32x32x16_bf16 v[32:47], v[128:131], v[112:115], v[32:47]
    ds_read_b64_tr_b16 v[158:159], v7 offset:18944
    ds_read_b128 v[108:111], v23 offset:0
    v_sub_u32 v4, v22, v164
    ds_read_b128 v[120:123], v4 offset:0
    v_mfma_f32_32x32x16_bf16 v[64:79], v[132:135], v[100:103], v[64:79]
    v_sub_u32 v5, v23, v164
    ds_read_b128 v[124:127], v5 offset:0
    v_mfma_f32_32x32x16_bf16 v[80:95], v[140:143], v[100:103], v[80:95]
    v_mfma_f32_32x32x16_bf16 v[32:47], v[132:135], v[116:119], v[32:47]
    s_waitcnt lgkmcnt(0)
    s_barrier
    v_mfma_f32_32x32x16_bf16 v[64:79], v[144:147], v[104:107], v[64:79]
    ds_read_b64_tr_b16 v[128:129], v6 offset:32768
    ds_read_b64_tr_b16 v[130:131], v6 offset:33280
    ds_read_b64_tr_b16 v[136:137], v7 offset:32768
    ds_read_b64_tr_b16 v[138:139], v7 offset:33280
    v_mfma_f32_32x32x16_bf16 v[80:95], v[152:155], v[104:107], v[80:95]
    ds_read_b128 v[96:99], v24 offset:0
    ds_read_b64_tr_b16 v[132:133], v6 offset:34816
    ds_read_b64_tr_b16 v[134:135], v6 offset:35328
    ds_read_b64_tr_b16 v[140:141], v7 offset:34816
    v_mfma_f32_32x32x16_bf16 v[32:47], v[144:147], v[120:123], v[32:47]
    ds_read_b64_tr_b16 v[142:143], v7 offset:35328
    ds_read_b128 v[100:103], v25 offset:0
    v_sub_u32 v4, v24, v164
    ds_read_b128 v[112:115], v4 offset:0
    v_mfma_f32_32x32x16_bf16 v[64:79], v[148:151], v[108:111], v[64:79]
    v_sub_u32 v5, v25, v164
    ds_read_b128 v[116:119], v5 offset:0
    v_mfma_f32_32x32x16_bf16 v[80:95], v[156:159], v[108:111], v[80:95]
    v_mfma_f32_32x32x16_bf16 v[32:47], v[148:151], v[124:127], v[32:47]
    s_waitcnt lgkmcnt(0)
    s_barrier
    v_mfma_f32_32x32x16_bf16 v[64:79], v[128:131], v[96:99], v[64:79]
    ds_read_b64_tr_b16 v[144:145], v6 offset:49152
    ds_read_b64_tr_b16 v[146:147], v6 offset:49664
    ds_read_b64_tr_b16 v[152:153], v7 offset:49152
    ds_read_b64_tr_b16 v[154:155], v7 offset:49664
    v_mfma_f32_32x32x16_bf16 v[80:95], v[136:139], v[96:99], v[80:95]
    ds_read_b128 v[104:107], v26 offset:0
    ds_read_b64_tr_b16 v[148:149], v6 offset:51200
    ds_read_b64_tr_b16 v[150:151], v6 offset:51712
    ds_read_b64_tr_b16 v[156:157], v7 offset:51200
    v_mfma_f32_32x32x16_bf16 v[32:47], v[128:131], v[112:115], v[32:47]
    ds_read_b64_tr_b16 v[158:159], v7 offset:51712
    ds_read_b128 v[108:111], v27 offset:0
    v_sub_u32 v4, v26, v164
    ds_read_b128 v[120:123], v4 offset:0
    v_mfma_f32_32x32x16_bf16 v[64:79], v[132:135], v[100:103], v[64:79]
    v_sub_u32 v5, v27, v164
    ds_read_b128 v[124:127], v5 offset:0
    v_mfma_f32_32x32x16_bf16 v[80:95], v[140:143], v[100:103], v[80:95]
    v_mfma_f32_32x32x16_bf16 v[32:47], v[132:135], v[116:119], v[32:47]
    s_waitcnt lgkmcnt(0)
    s_barrier
    v_mfma_f32_32x32x16_bf16 v[64:79], v[144:147], v[104:107], v[64:79]
    ds_read_b64_tr_b16 v[128:129], v6 offset:0
    ds_read_b64_tr_b16 v[130:131], v6 offset:512
    ds_read_b64_tr_b16 v[136:137], v7 offset:0
    ds_read_b64_tr_b16 v[138:139], v7 offset:512
    v_mfma_f32_32x32x16_bf16 v[80:95], v[152:155], v[104:107], v[80:95]
    ds_read_b128 v[96:99], v20 offset:20480
    ds_read_b64_tr_b16 v[132:133], v6 offset:2048
    ds_read_b64_tr_b16 v[134:135], v6 offset:2560
    ds_read_b64_tr_b16 v[140:141], v7 offset:2048
    v_mfma_f32_32x32x16_bf16 v[32:47], v[144:147], v[120:123], v[32:47]
    ds_read_b64_tr_b16 v[142:143], v7 offset:2560
    ds_read_b128 v[100:103], v21 offset:20480
    v_sub_u32 v4, v20, v164
    ds_read_b128 v[112:115], v4 offset:20480
    v_mfma_f32_32x32x16_bf16 v[64:79], v[148:151], v[108:111], v[64:79]
    v_sub_u32 v5, v21, v164
    ds_read_b128 v[116:119], v5 offset:20480
    v_mfma_f32_32x32x16_bf16 v[80:95], v[156:159], v[108:111], v[80:95]
    v_mfma_f32_32x32x16_bf16 v[32:47], v[148:151], v[124:127], v[32:47]
    s_waitcnt lgkmcnt(0)
    s_barrier
    v_mfma_f32_32x32x16_bf16 v[64:79], v[128:131], v[96:99], v[64:79]
    ds_read_b64_tr_b16 v[144:145], v6 offset:16384
    ds_read_b64_tr_b16 v[146:147], v6 offset:16896
    ds_read_b64_tr_b16 v[152:153], v7 offset:16384
    ds_read_b64_tr_b16 v[154:155], v7 offset:16896
    v_mfma_f32_32x32x16_bf16 v[80:95], v[136:139], v[96:99], v[80:95]
    ds_read_b128 v[104:107], v22 offset:20480
    ds_read_b64_tr_b16 v[148:149], v6 offset:18432
    ds_read_b64_tr_b16 v[150:151], v6 offset:18944
    ds_read_b64_tr_b16 v[156:157], v7 offset:18432
    v_mfma_f32_32x32x16_bf16 v[32:47], v[128:131], v[112:115], v[32:47]
    ds_read_b64_tr_b16 v[158:159], v7 offset:18944
    ds_read_b128 v[108:111], v23 offset:20480
    v_sub_u32 v4, v22, v164
    ds_read_b128 v[120:123], v4 offset:20480
    v_mfma_f32_32x32x16_bf16 v[64:79], v[132:135], v[100:103], v[64:79]
    v_sub_u32 v5, v23, v164
    ds_read_b128 v[124:127], v5 offset:20480
    v_mfma_f32_32x32x16_bf16 v[80:95], v[140:143], v[100:103], v[80:95]
    v_mfma_f32_32x32x16_bf16 v[32:47], v[132:135], v[116:119], v[32:47]
    s_waitcnt lgkmcnt(0)
    s_barrier
    v_mfma_f32_32x32x16_bf16 v[64:79], v[144:147], v[104:107], v[64:79]
    ds_read_b64_tr_b16 v[128:129], v6 offset:32768
    ds_read_b64_tr_b16 v[130:131], v6 offset:33280
    ds_read_b64_tr_b16 v[136:137], v7 offset:32768
    ds_read_b64_tr_b16 v[138:139], v7 offset:33280
    v_mfma_f32_32x32x16_bf16 v[80:95], v[152:155], v[104:107], v[80:95]
    ds_read_b128 v[96:99], v24 offset:20480
    ds_read_b64_tr_b16 v[132:133], v6 offset:34816
    ds_read_b64_tr_b16 v[134:135], v6 offset:35328
    ds_read_b64_tr_b16 v[140:141], v7 offset:34816
    v_mfma_f32_32x32x16_bf16 v[32:47], v[144:147], v[120:123], v[32:47]
    ds_read_b64_tr_b16 v[142:143], v7 offset:35328
    ds_read_b128 v[100:103], v25 offset:20480
    v_sub_u32 v4, v24, v164
    ds_read_b128 v[112:115], v4 offset:20480
    v_mfma_f32_32x32x16_bf16 v[64:79], v[148:151], v[108:111], v[64:79]
    v_sub_u32 v5, v25, v164
    ds_read_b128 v[116:119], v5 offset:20480
    v_mfma_f32_32x32x16_bf16 v[80:95], v[156:159], v[108:111], v[80:95]
    v_mfma_f32_32x32x16_bf16 v[32:47], v[148:151], v[124:127], v[32:47]
    s_waitcnt lgkmcnt(0)
    s_barrier
    v_mfma_f32_32x32x16_bf16 v[64:79], v[128:131], v[96:99], v[64:79]
    ds_read_b64_tr_b16 v[144:145], v6 offset:49152
    ds_read_b64_tr_b16 v[146:147], v6 offset:49664
    ds_read_b64_tr_b16 v[152:153], v7 offset:49152
    ds_read_b64_tr_b16 v[154:155], v7 offset:49664
    v_mfma_f32_32x32x16_bf16 v[80:95], v[136:139], v[96:99], v[80:95]
    ds_read_b128 v[104:107], v26 offset:20480
    ds_read_b64_tr_b16 v[148:149], v6 offset:51200
    ds_read_b64_tr_b16 v[150:151], v6 offset:51712
    ds_read_b64_tr_b16 v[156:157], v7 offset:51200
    v_mfma_f32_32x32x16_bf16 v[32:47], v[128:131], v[112:115], v[32:47]
    ds_read_b64_tr_b16 v[158:159], v7 offset:51712
    ds_read_b128 v[108:111], v27 offset:20480
    v_sub_u32 v4, v26, v164
    ds_read_b128 v[120:123], v4 offset:20480
    v_mfma_f32_32x32x16_bf16 v[64:79], v[132:135], v[100:103], v[64:79]
    v_sub_u32 v5, v27, v164
    ds_read_b128 v[124:127], v5 offset:20480
    v_mfma_f32_32x32x16_bf16 v[80:95], v[140:143], v[100:103], v[80:95]
    v_mfma_f32_32x32x16_bf16 v[32:47], v[132:135], v[116:119], v[32:47]
    s_waitcnt lgkmcnt(0)
    v_mfma_f32_32x32x16_bf16 v[64:79], v[144:147], v[104:107], v[64:79]
    v_mfma_f32_32x32x16_bf16 v[80:95], v[152:155], v[104:107], v[80:95]
    v_mfma_f32_32x32x16_bf16 v[32:47], v[144:147], v[120:123], v[32:47]
    v_mfma_f32_32x32x16_bf16 v[64:79], v[148:151], v[108:111], v[64:79]
    v_mfma_f32_32x32x16_bf16 v[80:95], v[156:159], v[108:111], v[80:95]
    v_mfma_f32_32x32x16_bf16 v[32:47], v[148:151], v[124:127], v[32:47]
    s_nop 9
    v_cvt_pk_bf16_f32 v128, v64, v65
    v_cvt_pk_bf16_f32 v129, v66, v67
    v_cvt_pk_bf16_f32 v130, v68, v69
    v_cvt_pk_bf16_f32 v131, v70, v71
    ds_write_b128 v160, v[128:131]
    v_cvt_pk_bf16_f32 v132, v72, v73
    v_cvt_pk_bf16_f32 v133, v74, v75
    v_cvt_pk_bf16_f32 v134, v76, v77
    v_cvt_pk_bf16_f32 v135, v78, v79
    ds_write_b128 v161, v[132:135]
    v_cvt_pk_bf16_f32 v136, v80, v81
    v_cvt_pk_bf16_f32 v137, v82, v83
    v_cvt_pk_bf16_f32 v138, v84, v85
    v_cvt_pk_bf16_f32 v139, v86, v87
    ds_write_b128 v162, v[136:139]
    v_cvt_pk_bf16_f32 v140, v88, v89
    v_cvt_pk_bf16_f32 v141, v90, v91
    v_cvt_pk_bf16_f32 v142, v92, v93
    v_cvt_pk_bf16_f32 v143, v94, v95
    ds_write_b128 v163, v[140:143]
    s_mov_b64 exec, s[92:93]
    v_cvt_pk_bf16_f32 v48, v32, v33
    v_cvt_pk_bf16_f32 v49, v34, v35
    v_cvt_pk_bf16_f32 v50, v36, v37
    v_cvt_pk_bf16_f32 v51, v38, v39
    ds_write_b128 v31, v[48:51] offset:0
    v_cvt_pk_bf16_f32 v52, v40, v41
    v_cvt_pk_bf16_f32 v53, v42, v43
    v_cvt_pk_bf16_f32 v54, v44, v45
    v_cvt_pk_bf16_f32 v55, v46, v47
    ds_write_b128 v31, v[52:55] offset:2560
    s_mov_b64 exec, -1
    s_branch L_aw_e
L_kv_skip:
    s_barrier
    s_barrier
    ds_read_b64_tr_b16 v[128:129], v6 offset:0
    ds_read_b64_tr_b16 v[130:131], v6 offset:512
    ds_read_b64_tr_b16 v[136:137], v7 offset:0
    ds_read_b64_tr_b16 v[138:139], v7 offset:512
    ds_read_b128 v[96:99], v20 offset:0
    ds_read_b64_tr_b16 v[132:133], v6 offset:2048
    ds_read_b64_tr_b16 v[134:135], v6 offset:2560
    ds_read_b64_tr_b16 v[140:141], v7 offset:2048
    ds_read_b64_tr_b16 v[142:143], v7 offset:2560
    ds_read_b128 v[100:103], v21 offset:0
    s_add_u32 m0, s57, 20480
    s_add_u32 s95, s61, s53
    buffer_load_dwordx4 v29, s[8:11], s95 offen lds
    s_add_u32 m0, s58, 20480
    s_add_u32 s95, s62, s53
    buffer_load_dwordx4 v29, s[8:11], s95 offen lds
    s_waitcnt lgkmcnt(0)
    s_barrier
    v_mfma_f32_32x32x16_bf16 v[64:79], v[128:131], v[96:99], 0
    ds_read_b64_tr_b16 v[144:145], v6 offset:16384
    ds_read_b64_tr_b16 v[146:147], v6 offset:16896
    ds_read_b64_tr_b16 v[152:153], v7 offset:16384
    ds_read_b64_tr_b16 v[154:155], v7 offset:16896
    v_mfma_f32_32x32x16_bf16 v[80:95], v[136:139], v[96:99], 0
    ds_read_b128 v[104:107], v22 offset:0
    ds_read_b64_tr_b16 v[148:149], v6 offset:18432
    ds_read_b64_tr_b16 v[150:151], v6 offset:18944
    ds_read_b64_tr_b16 v[156:157], v7 offset:18432
    v_mfma_f32_32x32x16_bf16 v[64:79], v[132:135], v[100:103], v[64:79]
    ds_read_b64_tr_b16 v[158:159], v7 offset:18944
    ds_read_b128 v[108:111], v23 offset:0
    v_mfma_f32_32x32x16_bf16 v[80:95], v[140:143], v[100:103], v[80:95]
    s_add_u32 m0, s59, 20480
    s_add_u32 s95, s63, s53
    buffer_load_dwordx4 v29, s[8:11], s95 offen lds
    s_add_u32 m0, s91, 20480
    s_add_u32 s95, s99, s53
    buffer_load_dwordx4 v29, s[8:11], s95 offen lds
    s_waitcnt lgkmcnt(0)
    s_barrier
    v_mfma_f32_32x32x16_bf16 v[64:79], v[144:147], v[104:107], v[64:79]
    ds_read_b64_tr_b16 v[128:129], v6 offset:32768
    ds_read_b64_tr_b16 v[130:131], v6 offset:33280
    ds_read_b64_tr_b16 v[136:137], v7 offset:32768
    ds_read_b64_tr_b16 v[138:139], v7 offset:33280
    v_mfma_f32_32x32x16_bf16 v[80:95], v[152:155], v[104:107], v[80:95]
    ds_read_b128 v[96:99], v24 offset:0
    ds_read_b64_tr_b16 v[132:133], v6 offset:34816
    ds_read_b64_tr_b16 v[134:135], v6 offset:35328
    ds_read_b64_tr_b16 v[140:141], v7 offset:34816
    v_mfma_f32_32x32x16_bf16 v[64:79], v[148:151], v[108:111], v[64:79]
    ds_read_b64_tr_b16 v[142:143], v7 offset:35328
    ds_read_b128 v[100:103], v25 offset:0
    v_mfma_f32_32x32x16_bf16 v[80:95], v[156:159], v[108:111], v[80:95]
    s_add_u32 m0, s57, 40960
    s_add_u32 s95, s61, s54
    buffer_load_dwordx4 v29, s[8:11], s95 offen lds
    s_waitcnt lgkmcnt(0)
    s_barrier
    v_mfma_f32_32x32x16_bf16 v[64:79], v[128:131], v[96:99], v[64:79]
    ds_read_b64_tr_b16 v[144:145], v6 offset:49152
    ds_read_b64_tr_b16 v[146:147], v6 offset:49664
    ds_read_b64_tr_b16 v[152:153], v7 offset:49152
    ds_read_b64_tr_b16 v[154:155], v7 offset:49664
    v_mfma_f32_32x32x16_bf16 v[80:95], v[136:139], v[96:99], v[80:95]
    ds_read_b128 v[104:107], v26 offset:0
    ds_read_b64_tr_b16 v[148:149], v6 offset:51200
    ds_read_b64_tr_b16 v[150:151], v6 offset:51712
    ds_read_b64_tr_b16 v[156:157], v7 offset:51200
    v_mfma_f32_32x32x16_bf16 v[64:79], v[132:135], v[100:103], v[64:79]
    ds_read_b64_tr_b16 v[158:159], v7 offset:51712
    ds_read_b128 v[108:111], v27 offset:0
    v_mfma_f32_32x32x16_bf16 v[80:95], v[140:143], v[100:103], v[80:95]
    s_add_u32 m0, s58, 40960
    s_add_u32 s95, s62, s54
    buffer_load_dwordx4 v29, s[8:11], s95 offen lds
    s_cmp_lg_u32 s3, 4
    s_cbranch_scc1 L_noarr
    s_and_b32 s48, s2, 3
    s_lshl_b32 s48, s48, 6
    v_mov_b32 v12, s48
    v_mov_b32 v13, 1
    s_mov_b64 exec, 1
    buffer_atomic_add v13, v12, s[20:23], 0 offen sc1
    s_mov_b64 exec, -1
L_noarr:
    s_waitcnt lgkmcnt(0)
    s_waitcnt vmcnt(2)
    s_barrier
    v_mfma_f32_32x32x16_bf16 v[64:79], v[144:147], v[104:107], v[64:79]
    ds_read_b64_tr_b16 v[128:129], v6 offset:0
    ds_read_b64_tr_b16 v[130:131], v6 offset:512
    ds_read_b64_tr_b16 v[136:137], v7 offset:0
    ds_read_b64_tr_b16 v[138:139], v7 offset:512
    v_mfma_f32_32x32x16_bf16 v[80:95], v[152:155], v[104:107], v[80:95]
    ds_read_b128 v[96:99], v20 offset:20480
    ds_read_b64_tr_b16 v[132:133], v6 offset:2048
    ds_read_b64_tr_b16 v[134:135], v6 offset:2560
    ds_read_b64_tr_b16 v[140:141], v7 offset:2048
    v_mfma_f32_32x32x16_bf16 v[64:79], v[148:151], v[108:111], v[64:79]
    ds_read_b64_tr_b16 v[142:143], v7 offset:2560
    ds_read_b128 v[100:103], v21 offset:20480
    v_mfma_f32_32x32x16_bf16 v[80:95], v[156:159], v[108:111], v[80:95]
    s_add_u32 m0, s59, 40960
    s_add_u32 s95, s63, s54
    buffer_load_dwordx4 v29, s[8:11], s95 offen lds
    s_waitcnt lgkmcnt(0)
    s_barrier
    v_mfma_f32_32x32x16_bf16 v[64:79], v[128:131], v[96:99], v[64:79]
    ds_read_b64_tr_b16 v[144:145], v6 offset:16384
    ds_read_b64_tr_b16 v[146:147], v6 offset:16896
    ds_read_b64_tr_b16 v[152:153], v7 offset:16384
    ds_read_b64_tr_b16 v[154:155], v7 offset:16896
    v_mfma_f32_32x32x16_bf16 v[80:95], v[136:139], v[96:99], v[80:95]
    ds_read_b128 v[104:107], v22 offset:20480
    ds_read_b64_tr_b16 v[148:149], v6 offset:18432
    ds_read_b64_tr_b16 v[150:151], v6 offset:18944
    ds_read_b64_tr_b16 v[156:157], v7 offset:18432
    v_mfma_f32_32x32x16_bf16 v[64:79], v[132:135], v[100:103], v[64:79]
    ds_read_b64_tr_b16 v[158:159], v7 offset:18944
    ds_read_b128 v[108:111], v23 offset:20480
    v_mfma_f32_32x32x16_bf16 v[80:95], v[140:143], v[100:103], v[80:95]
    s_add_u32 m0, s91, 40960
    s_add_u32 s95, s99, s54
    buffer_load_dwordx4 v29, s[8:11], s95 offen lds
    s_waitcnt lgkmcnt(0)
    s_barrier
    v_mfma_f32_32x32x16_bf16 v[64:79], v[144:147], v[104:107], v[64:79]
    ds_read_b64_tr_b16 v[128:129], v6 offset:32768
    ds_read_b64_tr_b16 v[130:131], v6 offset:33280
    ds_read_b64_tr_b16 v[136:137], v7 offset:32768
    ds_read_b64_tr_b16 v[138:139], v7 offset:33280
    v_mfma_f32_32x32x16_bf16 v[80:95], v[152:155], v[104:107], v[80:95]
    ds_read_b128 v[96:99], v24 offset:20480
    ds_read_b64_tr_b16 v[132:133], v6 offset:34816
    ds_read_b64_tr_b16 v[134:135], v6 offset:35328
    ds_read_b64_tr_b16 v[140:141], v7 offset:34816
    v_mfma_f32_32x32x16_bf16 v[64:79], v[148:151], v[108:111], v[64:79]
    ds_read_b64_tr_b16 v[142:143], v7 offset:35328
    ds_read_b128 v[100:103], v25 offset:20480
    v_mfma_f32_32x32x16_bf16 v[80:95], v[156:159], v[108:111], v[80:95]
    s_add_u32 m0, s57, 61440
    s_add_u32 s95, s61, s55
    buffer_load_dwordx4 v29, s[8:11], s95 offen lds
    s_waitcnt lgkmcnt(0)
    s_barrier
    v_mfma_f32_32x32x16_bf16 v[64:79], v[128:131], v[96:99], v[64:79]
    ds_read_b64_tr_b16 v[144:145], v6 offset:49152
    ds_read_b64_tr_b16 v[146:147], v6 offset:49664
    ds_read_b64_tr_b16 v[152:153], v7 offset:49152
    ds_read_b64_tr_b16 v[154:155], v7 offset:49664
    v_mfma_f32_32x32x16_bf16 v[80:95], v[136:139], v[96:99], v[80:95]
    ds_read_b128 v[104:107], v26 offset:20480
    ds_read_b64_tr_b16 v[148:149], v6 offset:51200
    ds_read_b64_tr_b16 v[150:151], v6 offset:51712
    ds_read_b64_tr_b16 v[156:157], v7 offset:51200
    v_mfma_f32_32x32x16_bf16 v[64:79], v[132:135], v[100:103], v[64:79]
    ds_read_b64_tr_b16 v[158:159], v7 offset:51712
    ds_read_b128 v[108:111], v27 offset:20480
    v_mfma_f32_32x32x16_bf16 v[80:95], v[140:143], v[100:103], v[80:95]
    s_add_u32 m0, s58, 61440
    s_add_u32 s95, s62, s55
    buffer_load_dwordx4 v29, s[8:11], s95 offen lds
    s_waitcnt lgkmcnt(0)
    s_waitcnt vmcnt(2)
    s_barrier
    v_add_u32 v20, 40960, v20
    v_add_u32 v21, 40960, v21
    v_add_u32 v22, 40960, v22
    v_add_u32 v23, 40960, v23
    v_add_u32 v24, 40960, v24
    v_add_u32 v25, 40960, v25
    v_add_u32 v26, 40960, v26
    v_add_u32 v27, 40960, v27
    v_mfma_f32_32x32x16_bf16 v[64:79], v[144:147], v[104:107], v[64:79]
    ds_read_b64_tr_b16 v[128:129], v6 offset:0
    ds_read_b64_tr_b16 v[130:131], v6 offset:512
    ds_read_b64_tr_b16 v[136:137], v7 offset:0
    ds_read_b64_tr_b16 v[138:139], v7 offset:512
    v_mfma_f32_32x32x16_bf16 v[80:95], v[152:155], v[104:107], v[80:95]
    ds_read_b128 v[96:99], v20 offset:0
    ds_read_b64_tr_b16 v[132:133], v6 offset:2048
    ds_read_b64_tr_b16 v[134:135], v6 offset:2560
    ds_read_b64_tr_b16 v[140:141], v7 offset:2048
    v_mfma_f32_32x32x16_bf16 v[64:79], v[148:151], v[108:111], v[64:79]
    ds_read_b64_tr_b16 v[142:143], v7 offset:2560
    ds_read_b128 v[100:103], v21 offset:0
    v_mfma_f32_32x32x16_bf16 v[80:95], v[156:159], v[108:111], v[80:95]
    s_add_u32 m0, s59, 61440
    s_add_u32 s95, s63, s55
    buffer_load_dwordx4 v29, s[8:11], s95 offen lds
    s_waitcnt lgkmcnt(0)
    s_barrier
    v_mfma_f32_32x32x16_bf16 v[64:79], v[128:131], v[96:99], v[64:79]
    ds_read_b64_tr_b16 v[144:145], v6 offset:16384
    ds_read_b64_tr_b16 v[146:147], v6 offset:16896
    ds_read_b64_tr_b16 v[152:153], v7 offset:16384
    ds_read_b64_tr_b16 v[154:155], v7 offset:16896
    v_mfma_f32_32x32x16_bf16 v[80:95], v[136:139], v[96:99], v[80:95]
    ds_read_b128 v[104:107], v22 offset:0
    ds_read_b64_tr_b16 v[148:149], v6 offset:18432
    ds_read_b64_tr_b16 v[150:151], v6 offset:18944
    ds_read_b64_tr_b16 v[156:157], v7 offset:18432
    v_mfma_f32_32x32x16_bf16 v[64:79], v[132:135], v[100:103], v[64:79]
    ds_read_b64_tr_b16 v[158:159], v7 offset:18944
    ds_read_b128 v[108:111], v23 offset:0
    v_mfma_f32_32x32x16_bf16 v[80:95], v[140:143], v[100:103], v[80:95]
    s_add_u32 m0, s91, 61440
    s_add_u32 s95, s99, s55
    buffer_load_dwordx4 v29, s[8:11], s95 offen lds
    s_waitcnt lgkmcnt(0)
    s_barrier
    v_mfma_f32_32x32x16_bf16 v[64:79], v[144:147], v[104:107], v[64:79]
    ds_read_b64_tr_b16 v[128:129], v6 offset:32768
    ds_read_b64_tr_b16 v[130:131], v6 offset:33280
    ds_read_b64_tr_b16 v[136:137], v7 offset:32768
    ds_read_b64_tr_b16 v[138:139], v7 offset:33280
    v_mfma_f32_32x32x16_bf16 v[80:95], v[152:155], v[104:107], v[80:95]
    ds_read_b128 v[96:99], v24 offset:0
    ds_read_b64_tr_b16 v[132:133], v6 offset:34816
    ds_read_b64_tr_b16 v[134:135], v6 offset:35328
    ds_read_b64_tr_b16 v[140:141], v7 offset:34816
    v_mfma_f32_32x32x16_bf16 v[64:79], v[148:151], v[108:111], v[64:79]
    ds_read_b64_tr_b16 v[142:143], v7 offset:35328
    ds_read_b128 v[100:103], v25 offset:0
    v_mfma_f32_32x32x16_bf16 v[80:95], v[156:159], v[108:111], v[80:95]
    s_waitcnt lgkmcnt(0)
    s_barrier
    v_mfma_f32_32x32x16_bf16 v[64:79], v[128:131], v[96:99], v[64:79]
    ds_read_b64_tr_b16 v[144:145], v6 offset:49152
    ds_read_b64_tr_b16 v[146:147], v6 offset:49664
    ds_read_b64_tr_b16 v[152:153], v7 offset:49152
    ds_read_b64_tr_b16 v[154:155], v7 offset:49664
    v_mfma_f32_32x32x16_bf16 v[80:95], v[136:139], v[96:99], v[80:95]
    ds_read_b128 v[104:107], v26 offset:0
    ds_read_b64_tr_b16 v[148:149], v6 offset:51200
    ds_read_b64_tr_b16 v[150:151], v6 offset:51712
    ds_read_b64_tr_b16 v[156:157], v7 offset:51200
    v_mfma_f32_32x32x16_bf16 v[64:79], v[132:135], v[100:103], v[64:79]
    ds_read_b64_tr_b16 v[158:159], v7 offset:51712
    ds_read_b128 v[108:111], v27 offset:0
    v_mfma_f32_32x32x16_bf16 v[80:95], v[140:143], v[100:103], v[80:95]
    s_waitcnt lgkmcnt(0)
    s_waitcnt vmcnt(0)
    s_barrier
    v_mfma_f32_32x32x16_bf16 v[64:79], v[144:147], v[104:107], v[64:79]
    ds_read_b64_tr_b16 v[128:129], v6 offset:0
    ds_read_b64_tr_b16 v[130:131], v6 offset:512
    ds_read_b64_tr_b16 v[136:137], v7 offset:0
    ds_read_b64_tr_b16 v[138:139], v7 offset:512
    v_mfma_f32_32x32x16_bf16 v[80:95], v[152:155], v[104:107], v[80:95]
    ds_read_b128 v[96:99], v20 offset:20480
    ds_read_b64_tr_b16 v[132:133], v6 offset:2048
    ds_read_b64_tr_b16 v[134:135], v6 offset:2560
    ds_read_b64_tr_b16 v[140:141], v7 offset:2048
    v_mfma_f32_32x32x16_bf16 v[64:79], v[148:151], v[108:111], v[64:79]
    ds_read_b64_tr_b16 v[142:143], v7 offset:2560
    ds_read_b128 v[100:103], v21 offset:20480
    v_mfma_f32_32x32x16_bf16 v[80:95], v[156:159], v[108:111], v[80:95]
    s_waitcnt lgkmcnt(0)
    s_barrier
    v_mfma_f32_32x32x16_bf16 v[64:79], v[128:131], v[96:99], v[64:79]
    ds_read_b64_tr_b16 v[144:145], v6 offset:16384
    ds_read_b64_tr_b16 v[146:147], v6 offset:16896
    ds_read_b64_tr_b16 v[152:153], v7 offset:16384
    ds_read_b64_tr_b16 v[154:155], v7 offset:16896
    v_mfma_f32_32x32x16_bf16 v[80:95], v[136:139], v[96:99], v[80:95]
    ds_read_b128 v[104:107], v22 offset:20480
    ds_read_b64_tr_b16 v[148:149], v6 offset:18432
    ds_read_b64_tr_b16 v[150:151], v6 offset:18944
    ds_read_b64_tr_b16 v[156:157], v7 offset:18432
    v_mfma_f32_32x32x16_bf16 v[64:79], v[132:135], v[100:103], v[64:79]
    ds_read_b64_tr_b16 v[158:159], v7 offset:18944
    ds_read_b128 v[108:111], v23 offset:20480
    v_mfma_f32_32x32x16_bf16 v[80:95], v[140:143], v[100:103], v[80:95]
    s_waitcnt lgkmcnt(0)
    s_barrier
    v_mfma_f32_32x32x16_bf16 v[64:79], v[144:147], v[104:107], v[64:79]
    ds_read_b64_tr_b16 v[128:129], v6 offset:32768
    ds_read_b64_tr_b16 v[130:131], v6 offset:33280
    ds_read_b64_tr_b16 v[136:137], v7 offset:32768
    ds_read_b64_tr_b16 v[138:139], v7 offset:33280
    v_mfma_f32_32x32x16_bf16 v[80:95], v[152:155], v[104:107], v[80:95]
    ds_read_b128 v[96:99], v24 offset:20480
    ds_read_b64_tr_b16 v[132:133], v6 offset:34816
    ds_read_b64_tr_b16 v[134:135], v6 offset:35328
    ds_read_b64_tr_b16 v[140:141], v7 offset:34816
    v_mfma_f32_32x32x16_bf16 v[64:79], v[148:151], v[108:111], v[64:79]
    ds_read_b64_tr_b16 v[142:143], v7 offset:35328
    ds_read_b128 v[100:103], v25 offset:20480
    v_mfma_f32_32x32x16_bf16 v[80:95], v[156:159], v[108:111], v[80:95]
    s_waitcnt lgkmcnt(0)
    s_barrier
    v_mfma_f32_32x32x16_bf16 v[64:79], v[128:131], v[96:99], v[64:79]
    ds_read_b64_tr_b16 v[144:145], v6 offset:49152
    ds_read_b64_tr_b16 v[146:147], v6 offset:49664
    ds_read_b64_tr_b16 v[152:153], v7 offset:49152
    ds_read_b64_tr_b16 v[154:155], v7 offset:49664
    v_mfma_f32_32x32x16_bf16 v[80:95], v[136:139], v[96:99], v[80:95]
    ds_read_b128 v[104:107], v26 offset:20480
    ds_read_b64_tr_b16 v[148:149], v6 offset:51200
    ds_read_b64_tr_b16 v[150:151], v6 offset:51712
    ds_read_b64_tr_b16 v[156:157], v7 offset:51200
    v_mfma_f32_32x32x16_bf16 v[64:79], v[132:135], v[100:103], v[64:79]
    ds_read_b64_tr_b16 v[158:159], v7 offset:51712
    ds_read_b128 v[108:111], v27 offset:20480
    v_mfma_f32_32x32x16_bf16 v[80:95], v[140:143], v[100:103], v[80:95]
    s_waitcnt lgkmcnt(0)
    v_mfma_f32_32x32x16_bf16 v[64:79], v[144:147], v[104:107], v[64:79]
    v_mfma_f32_32x32x16_bf16 v[80:95], v[152:155], v[104:107], v[80:95]
    v_mfma_f32_32x32x16_bf16 v[64:79], v[148:151], v[108:111], v[64:79]
    v_mfma_f32_32x32x16_bf16 v[80:95], v[156:159], v[108:111], v[80:95]
    s_nop 10
    v_cvt_pk_bf16_f32 v128, v64, v65
    v_cvt_pk_bf16_f32 v129, v66, v67
    v_cvt_pk_bf16_f32 v130, v68, v69
    v_cvt_pk_bf16_f32 v131, v70, v71
    ds_write_b128 v160, v[128:131]
    v_cvt_pk_bf16_f32 v132, v72, v73
    v_cvt_pk_bf16_f32 v133, v74, v75
    v_cvt_pk_bf16_f32 v134, v76, v77
    v_cvt_pk_bf16_f32 v135, v78, v79
    ds_write_b128 v161, v[132:135]
    v_cvt_pk_bf16_f32 v136, v80, v81
    v_cvt_pk_bf16_f32 v137, v82, v83
    v_cvt_pk_bf16_f32 v138, v84, v85
    v_cvt_pk_bf16_f32 v139, v86, v87
    ds_write_b128 v162, v[136:139]
    v_cvt_pk_bf16_f32 v140, v88, v89
    v_cvt_pk_bf16_f32 v141, v90, v91
    v_cvt_pk_bf16_f32 v142, v92, v93
    v_cvt_pk_bf16_f32 v143, v94, v95
    ds_write_b128 v163, v[140:143]
L_aw_e:
    v_and_b32 v9, 27, v19
    v_cmp_eq_u32 vcc, 16, v9
    v_mov_b32 v9, 0x3f803f80
    s_nop 0
    v_cndmask_b32 v112, 0, v9, vcc
    v_mov_b32 v113, v112
    v_mov_b32 v114, v112
    v_mov_b32 v115, v112
    v_mov_b32 v116, v112
    v_mov_b32 v117, v112
    v_mov_b32 v118, v112
    v_mov_b32 v119, v112
    v_mov_b32 v120, v112
    v_mov_b32 v121, v112
    v_mov_b32 v122, v112
    v_mov_b32 v123, v112
    v_mov_b32 v124, v112
    v_mov_b32 v125, v112
    v_mov_b32 v126, v112
    v_mov_b32 v127, v112
    v_bfe_u32 v8, v1, 2, 3
    s_and_b32 s48, s3, 1
    s_lshl_b32 s48, s48, 3
    v_add_u32 v8, s48, v8
    v_lshlrev_b32 v8, 2, v8
    s_lshr_b32 s48, s3, 1
    s_lshl_b32 s49, s4, 2
    s_add_u32 s48, s48, s49
    s_lshl_b32 s48, s48, 7
    s_add_u32 s48, s48, 180224
    v_mov_b32 v13, 129024
    v_mov_b32 v32, 0
    s_waitcnt lgkmcnt(0)
    s_barrier
    ds_read_b128 v[4:7], v30
    ds_read_b32 v34, v13
    ds_read_b128 v[104:107], v17
    ds_read_b128 v[108:111], v17 offset:1024
    s_mov_b64 exec, s[92:93]
    ds_read_b128 v[112:115], v18
    ds_read_b128 v[116:119], v18 offset:512
    s_mov_b64 exec, -1
    buffer_load_dword v10, v8, s[16:19], s48 offen sc1
    s_waitcnt lgkmcnt(4)
    v_dot2_f32_bf16 v32, v4, v4, v32
    v_dot2_f32_bf16 v32, v5, v5, v32
    v_dot2_f32_bf16 v32, v6, v6, v32
    v_dot2_f32_bf16 v32, v7, v7, v32
    s_nop 2
    v_mov_b32 v33, v32
    s_nop 1
    v_permlane32_swap_b32 v32, v33
    v_add_f32 v32, v32, v33
    v_mul_f32 v32, v32, v34
    v_sqrt_f32 v32, v32
    s_nop 0
    v_sub_f32 v32, 0, v32
    v_mov_b32 v33, v32
    v_mov_b32 v34, v32
    v_mov_b32 v35, v32
    v_mov_b32 v36, v32
    v_mov_b32 v37, v32
    v_mov_b32 v38, v32
    v_mov_b32 v39, v32
    v_mov_b32 v40, v32
    v_mov_b32 v41, v32
    v_mov_b32 v42, v32
    v_mov_b32 v43, v32
    v_mov_b32 v44, v32
    v_mov_b32 v45, v32
    v_mov_b32 v46, v32
    v_mov_b32 v47, v32
    s_waitcnt lgkmcnt(3)
    s_nop 0
    v_mfma_f32_32x32x16_bf16 v[48:63], v[104:107], v[4:7], v[32:47]
    ds_read_b128 v[104:107], v17 offset:2048
    s_setprio 2
    s_waitcnt lgkmcnt(3)
    v_mfma_f32_32x32x16_bf16 v[64:79], v[108:111], v[4:7], v[32:47]
    ds_read_b128 v[108:111], v17 offset:3072
    s_nop 6
    v_exp_f32 v48, v48
    v_exp_f32 v49, v49
    v_exp_f32 v50, v50
    v_exp_f32 v51, v51
    v_exp_f32 v52, v52
    v_exp_f32 v53, v53
    s_mov_b64 exec, s[92:93]
    ds_read_b128 v[120:123], v18 offset:1024
    ds_read_b128 v[124:127], v18 offset:1536
    s_mov_b64 exec, -1
    v_exp_f32 v54, v54
    v_exp_f32 v55, v55
    v_cvt_pk_bf16_f32 v96, v48, v49
    v_cvt_pk_bf16_f32 v97, v50, v51
    v_cvt_pk_bf16_f32 v98, v52, v53
    v_cvt_pk_bf16_f32 v99, v54, v55
    v_exp_f32 v56, v56
    v_exp_f32 v57, v57
    v_exp_f32 v58, v58
    s_waitcnt lgkmcnt(3)
    v_mfma_f32_32x32x16_bf16 v[80:95], v[112:115], v[96:99], 0
    v_exp_f32 v59, v59
    v_exp_f32 v60, v60
    v_exp_f32 v61, v61
    v_exp_f32 v62, v62
    v_exp_f32 v63, v63
    v_cvt_pk_bf16_f32 v100, v56, v57
    v_cvt_pk_bf16_f32 v101, v58, v59
    v_cvt_pk_bf16_f32 v102, v60, v61
    v_cvt_pk_bf16_f32 v103, v62, v63
    s_setprio 1
    v_mfma_f32_32x32x16_bf16 v[48:63], v[104:107], v[4:7], v[32:47]
    ds_read_b128 v[104:107], v17 offset:4096
    v_exp_f32 v64, v64
    v_exp_f32 v65, v65
    v_exp_f32 v66, v66
    v_exp_f32 v67, v67
    v_exp_f32 v68, v68
    v_exp_f32 v69, v69
    v_mfma_f32_32x32x16_bf16 v[80:95], v[116:119], v[100:103], v[80:95]
    s_mov_b64 exec, s[92:93]
    ds_read_b128 v[112:115], v18 offset:2048
    ds_read_b128 v[116:119], v18 offset:2560
    s_mov_b64 exec, -1
    v_exp_f32 v70, v70
    v_exp_f32 v71, v71
    v_cvt_pk_bf16_f32 v96, v64, v65
    v_cvt_pk_bf16_f32 v97, v66, v67
    v_cvt_pk_bf16_f32 v98, v68, v69
    v_cvt_pk_bf16_f32 v99, v70, v71
    v_exp_f32 v72, v72
    v_exp_f32 v73, v73
    v_exp_f32 v74, v74
    s_waitcnt lgkmcnt(3)
    v_mfma_f32_32x32x16_bf16 v[80:95], v[120:123], v[96:99], v[80:95]
    v_exp_f32 v75, v75
    v_exp_f32 v76, v76
    v_exp_f32 v77, v77
    v_exp_f32 v78, v78
    v_exp_f32 v79, v79
    v_cvt_pk_bf16_f32 v100, v72, v73
    v_cvt_pk_bf16_f32 v101, v74, v75
    v_cvt_pk_bf16_f32 v102, v76, v77
    v_cvt_pk_bf16_f32 v103, v78, v79
    v_mfma_f32_32x32x16_bf16 v[64:79], v[108:111], v[4:7], v[32:47]
    ds_read_b128 v[108:111], v17 offset:5120
    v_exp_f32 v48, v48
    v_exp_f32 v49, v49
    v_exp_f32 v50, v50
    v_exp_f32 v51, v51
    v_exp_f32 v52, v52
    v_exp_f32 v53, v53
    v_mfma_f32_32x32x16_bf16 v[80:95], v[124:127], v[100:103], v[80:95]
    s_mov_b64 exec, s[92:93]
    ds_read_b128 v[120:123], v18 offset:3072
    ds_read_b128 v[124:127], v18 offset:3584
    s_mov_b64 exec, -1
    v_exp_f32 v54, v54
    v_exp_f32 v55, v55
    v_cvt_pk_bf16_f32 v96, v48, v49
    v_cvt_pk_bf16_f32 v97, v50, v51
    v_cvt_pk_bf16_f32 v98, v52, v53
    v_cvt_pk_bf16_f32 v99, v54, v55
    v_exp_f32 v56, v56
    v_exp_f32 v57, v57
    v_exp_f32 v58, v58
    s_waitcnt lgkmcnt(3)
    v_mfma_f32_32x32x16_bf16 v[80:95], v[112:115], v[96:99], v[80:95]
    v_exp_f32 v59, v59
    v_exp_f32 v60, v60
    v_exp_f32 v61, v61
    v_exp_f32 v62, v62
    v_exp_f32 v63, v63
    v_cvt_pk_bf16_f32 v100, v56, v57
    v_cvt_pk_bf16_f32 v101, v58, v59
    v_cvt_pk_bf16_f32 v102, v60, v61
    v_cvt_pk_bf16_f32 v103, v62, v63
    v_mfma_f32_32x32x16_bf16 v[48:63], v[104:107], v[4:7], v[32:47]
    ds_read_b128 v[104:107], v17 offset:6144
    v_exp_f32 v64, v64
    v_exp_f32 v65, v65
    v_exp_f32 v66, v66
    v_exp_f32 v67, v67
    v_exp_f32 v68, v68
    v_exp_f32 v69, v69
    v_mfma_f32_32x32x16_bf16 v[80:95], v[116:119], v[100:103], v[80:95]
    s_mov_b64 exec, s[92:93]
    ds_read_b128 v[112:115], v18 offset:4096
    ds_read_b128 v[116:119], v18 offset:4608
    s_mov_b64 exec, -1
    v_exp_f32 v70, v70
    v_exp_f32 v71, v71
    v_cvt_pk_bf16_f32 v96, v64, v65
    v_cvt_pk_bf16_f32 v97, v66, v67
    v_cvt_pk_bf16_f32 v98, v68, v69
    v_cvt_pk_bf16_f32 v99, v70, v71
    v_exp_f32 v72, v72
    v_exp_f32 v73, v73
    v_exp_f32 v74, v74
    s_waitcnt lgkmcnt(3)
    v_mfma_f32_32x32x16_bf16 v[80:95], v[120:123], v[96:99], v[80:95]
    v_exp_f32 v75, v75
    v_exp_f32 v76, v76
    v_exp_f32 v77, v77
    v_exp_f32 v78, v78
    v_exp_f32 v79, v79
    v_cvt_pk_bf16_f32 v100, v72, v73
    v_cvt_pk_bf16_f32 v101, v74, v75
    v_cvt_pk_bf16_f32 v102, v76, v77
    v_cvt_pk_bf16_f32 v103, v78, v79
    s_setprio 0
    v_mfma_f32_32x32x16_bf16 v[64:79], v[108:111], v[4:7], v[32:47]
    ds_read_b128 v[108:111], v17 offset:7168
    v_exp_f32 v48, v48
    v_exp_f32 v49, v49
    v_exp_f32 v50, v50
    v_exp_f32 v51, v51
    v_exp_f32 v52, v52
    v_exp_f32 v53, v53
    v_mfma_f32_32x32x16_bf16 v[80:95], v[124:127], v[100:103], v[80:95]
    s_mov_b64 exec, s[92:93]
    ds_read_b128 v[120:123], v18 offset:5120
    ds_read_b128 v[124:127], v18 offset:5632
    s_mov_b64 exec, -1
    v_exp_f32 v54, v54
    v_exp_f32 v55, v55
    v_cvt_pk_bf16_f32 v96, v48, v49
    v_cvt_pk_bf16_f32 v97, v50, v51
    v_cvt_pk_bf16_f32 v98, v52, v53
    v_cvt_pk_bf16_f32 v99, v54, v55
    v_exp_f32 v56, v56
    v_exp_f32 v57, v57
    v_exp_f32 v58, v58
    s_waitcnt lgkmcnt(3)
    v_mfma_f32_32x32x16_bf16 v[80:95], v[112:115], v[96:99], v[80:95]
    v_exp_f32 v59, v59
    v_exp_f32 v60, v60
    v_exp_f32 v61, v61
    v_exp_f32 v62, v62
    v_exp_f32 v63, v63
    v_cvt_pk_bf16_f32 v100, v56, v57
    v_cvt_pk_bf16_f32 v101, v58, v59
    v_cvt_pk_bf16_f32 v102, v60, v61
    v_cvt_pk_bf16_f32 v103, v62, v63
    s_setprio 2
    v_mfma_f32_32x32x16_bf16 v[48:63], v[104:107], v[4:7], v[32:47]
    ds_read_b128 v[104:107], v17 offset:16384
    v_exp_f32 v64, v64
    v_exp_f32 v65, v65
    v_exp_f32 v66, v66
    v_exp_f32 v67, v67
    v_exp_f32 v68, v68
    v_exp_f32 v69, v69
    v_mfma_f32_32x32x16_bf16 v[80:95], v[116:119], v[100:103], v[80:95]
    s_mov_b64 exec, s[92:93]
    ds_read_b128 v[112:115], v18 offset:6144
    ds_read_b128 v[116:119], v18 offset:6656
    s_mov_b64 exec, -1
    v_exp_f32 v70, v70
    v_exp_f32 v71, v71
    v_cvt_pk_bf16_f32 v96, v64, v65
    v_cvt_pk_bf16_f32 v97, v66, v67
    v_cvt_pk_bf16_f32 v98, v68, v69
    v_cvt_pk_bf16_f32 v99, v70, v71
    v_exp_f32 v72, v72
    v_exp_f32 v73, v73
    v_exp_f32 v74, v74
    s_waitcnt lgkmcnt(3)
    v_mfma_f32_32x32x16_bf16 v[80:95], v[120:123], v[96:99], v[80:95]
    v_exp_f32 v75, v75
    v_exp_f32 v76, v76
    v_exp_f32 v77, v77
    v_exp_f32 v78, v78
    v_exp_f32 v79, v79
    v_cvt_pk_bf16_f32 v100, v72, v73
    v_cvt_pk_bf16_f32 v101, v74, v75
    v_cvt_pk_bf16_f32 v102, v76, v77
    v_cvt_pk_bf16_f32 v103, v78, v79
    v_mfma_f32_32x32x16_bf16 v[64:79], v[108:111], v[4:7], v[32:47]
    ds_read_b128 v[108:111], v17 offset:17408
    v_exp_f32 v48, v48
    v_exp_f32 v49, v49
    v_exp_f32 v50, v50
    v_exp_f32 v51, v51
    v_exp_f32 v52, v52
    v_exp_f32 v53, v53
    v_mfma_f32_32x32x16_bf16 v[80:95], v[124:127], v[100:103], v[80:95]
    s_mov_b64 exec, s[92:93]
    ds_read_b128 v[120:123], v18 offset:7168
    ds_read_b128 v[124:127], v18 offset:7680
    s_mov_b64 exec, -1
    v_exp_f32 v54, v54
    v_exp_f32 v55, v55
    v_cvt_pk_bf16_f32 v96, v48, v49
    v_cvt_pk_bf16_f32 v97, v50, v51
    v_cvt_pk_bf16_f32 v98, v52, v53
    v_cvt_pk_bf16_f32 v99, v54, v55
    v_exp_f32 v56, v56
    v_exp_f32 v57, v57
    v_exp_f32 v58, v58
    s_waitcnt lgkmcnt(3)
    v_mfma_f32_32x32x16_bf16 v[80:95], v[112:115], v[96:99], v[80:95]
    v_exp_f32 v59, v59
    v_exp_f32 v60, v60
    v_exp_f32 v61, v61
    v_exp_f32 v62, v62
    v_exp_f32 v63, v63
    v_cvt_pk_bf16_f32 v100, v56, v57
    v_cvt_pk_bf16_f32 v101, v58, v59
    v_cvt_pk_bf16_f32 v102, v60, v61
    v_cvt_pk_bf16_f32 v103, v62, v63
    v_mfma_f32_32x32x16_bf16 v[48:63], v[104:107], v[4:7], v[32:47]
    ds_read_b128 v[104:107], v17 offset:18432
    v_exp_f32 v64, v64
    v_exp_f32 v65, v65
    v_exp_f32 v66, v66
    v_exp_f32 v67, v67
    v_exp_f32 v68, v68
    v_exp_f32 v69, v69
    v_mfma_f32_32x32x16_bf16 v[80:95], v[116:119], v[100:103], v[80:95]
    s_mov_b64 exec, s[92:93]
    ds_read_b128 v[112:115], v18 offset:16384
    ds_read_b128 v[116:119], v18 offset:16896
    s_mov_b64 exec, -1
    v_exp_f32 v70, v70
    v_exp_f32 v71, v71
    v_cvt_pk_bf16_f32 v96, v64, v65
    v_cvt_pk_bf16_f32 v97, v66, v67
    v_cvt_pk_bf16_f32 v98, v68, v69
    v_cvt_pk_bf16_f32 v99, v70, v71
    v_exp_f32 v72, v72
    v_exp_f32 v73, v73
    v_exp_f32 v74, v74
    s_waitcnt lgkmcnt(3)
    v_mfma_f32_32x32x16_bf16 v[80:95], v[120:123], v[96:99], v[80:95]
    v_exp_f32 v75, v75
    v_exp_f32 v76, v76
    v_exp_f32 v77, v77
    v_exp_f32 v78, v78
    v_exp_f32 v79, v79
    v_cvt_pk_bf16_f32 v100, v72, v73
    v_cvt_pk_bf16_f32 v101, v74, v75
    v_cvt_pk_bf16_f32 v102, v76, v77
    v_cvt_pk_bf16_f32 v103, v78, v79
    v_mfma_f32_32x32x16_bf16 v[64:79], v[108:111], v[4:7], v[32:47]
    ds_read_b128 v[108:111], v17 offset:19456
    v_exp_f32 v48, v48
    v_exp_f32 v49, v49
    v_exp_f32 v50, v50
    v_exp_f32 v51, v51
    v_exp_f32 v52, v52
    v_exp_f32 v53, v53
    v_mfma_f32_32x32x16_bf16 v[80:95], v[124:127], v[100:103], v[80:95]
    s_mov_b64 exec, s[92:93]
    ds_read_b128 v[120:123], v18 offset:17408
    ds_read_b128 v[124:127], v18 offset:17920
    s_mov_b64 exec, -1
    v_exp_f32 v54, v54
    v_exp_f32 v55, v55
    v_cvt_pk_bf16_f32 v96, v48, v49
    v_cvt_pk_bf16_f32 v97, v50, v51
    v_cvt_pk_bf16_f32 v98, v52, v53
    v_cvt_pk_bf16_f32 v99, v54, v55
    v_exp_f32 v56, v56
    v_exp_f32 v57, v57
    v_exp_f32 v58, v58
    s_waitcnt lgkmcnt(3)
    v_mfma_f32_32x32x16_bf16 v[80:95], v[112:115], v[96:99], v[80:95]
    v_exp_f32 v59, v59
    v_exp_f32 v60, v60
    v_exp_f32 v61, v61
    v_exp_f32 v62, v62
    v_exp_f32 v63, v63
    v_cvt_pk_bf16_f32 v100, v56, v57
    v_cvt_pk_bf16_f32 v101, v58, v59
    v_cvt_pk_bf16_f32 v102, v60, v61
    v_cvt_pk_bf16_f32 v103, v62, v63
    s_setprio 1
    v_mfma_f32_32x32x16_bf16 v[48:63], v[104:107], v[4:7], v[32:47]
    ds_read_b128 v[104:107], v17 offset:20480
    v_exp_f32 v64, v64
    v_exp_f32 v65, v65
    v_exp_f32 v66, v66
    v_exp_f32 v67, v67
    v_exp_f32 v68, v68
    v_exp_f32 v69, v69
    v_mfma_f32_32x32x16_bf16 v[80:95], v[116:119], v[100:103], v[80:95]
    s_mov_b64 exec, s[92:93]
    ds_read_b128 v[112:115], v18 offset:18432
    ds_read_b128 v[116:119], v18 offset:18944
    s_mov_b64 exec, -1
    v_exp_f32 v70, v70
    v_exp_f32 v71, v71
    v_cvt_pk_bf16_f32 v96, v64, v65
    v_cvt_pk_bf16_f32 v97, v66, v67
    v_cvt_pk_bf16_f32 v98, v68, v69
    v_cvt_pk_bf16_f32 v99, v70, v71
    v_exp_f32 v72, v72
    v_exp_f32 v73, v73
    v_exp_f32 v74, v74
    s_waitcnt lgkmcnt(3)
    v_mfma_f32_32x32x16_bf16 v[80:95], v[120:123], v[96:99], v[80:95]
    v_exp_f32 v75, v75
    v_exp_f32 v76, v76
    v_exp_f32 v77, v77
    v_exp_f32 v78, v78
    v_exp_f32 v79, v79
    v_cvt_pk_bf16_f32 v100, v72, v73
    v_cvt_pk_bf16_f32 v101, v74, v75
    v_cvt_pk_bf16_f32 v102, v76, v77
    v_cvt_pk_bf16_f32 v103, v78, v79
    v_mfma_f32_32x32x16_bf16 v[64:79], v[108:111], v[4:7], v[32:47]
    ds_read_b128 v[108:111], v17 offset:21504
    v_exp_f32 v48, v48
    v_exp_f32 v49, v49
    v_exp_f32 v50, v50
    v_exp_f32 v51, v51
    v_exp_f32 v52, v52
    v_exp_f32 v53, v53
    v_mfma_f32_32x32x16_bf16 v[80:95], v[124:127], v[100:103], v[80:95]
    s_mov_b64 exec, s[92:93]
    ds_read_b128 v[120:123], v18 offset:19456
    ds_read_b128 v[124:127], v18 offset:19968
    s_mov_b64 exec, -1
    v_exp_f32 v54, v54
    v_exp_f32 v55, v55
    v_cvt_pk_bf16_f32 v96, v48, v49
    v_cvt_pk_bf16_f32 v97, v50, v51
    v_cvt_pk_bf16_f32 v98, v52, v53
    v_cvt_pk_bf16_f32 v99, v54, v55
    v_exp_f32 v56, v56
    v_exp_f32 v57, v57
    v_exp_f32 v58, v58
    s_waitcnt lgkmcnt(3)
    v_mfma_f32_32x32x16_bf16 v[80:95], v[112:115], v[96:99], v[80:95]
    v_exp_f32 v59, v59
    v_exp_f32 v60, v60
    v_exp_f32 v61, v61
    v_exp_f32 v62, v62
    v_exp_f32 v63, v63
    v_cvt_pk_bf16_f32 v100, v56, v57
    v_cvt_pk_bf16_f32 v101, v58, v59
    v_cvt_pk_bf16_f32 v102, v60, v61
    v_cvt_pk_bf16_f32 v103, v62, v63
    v_mfma_f32_32x32x16_bf16 v[48:63], v[104:107], v[4:7], v[32:47]
    ds_read_b128 v[104:107], v17 offset:22528
    v_exp_f32 v64, v64
    v_exp_f32 v65, v65
    v_exp_f32 v66, v66
    v_exp_f32 v67, v67
    v_exp_f32 v68, v68
    v_exp_f32 v69, v69
    v_mfma_f32_32x32x16_bf16 v[80:95], v[116:119], v[100:103], v[80:95]
    s_mov_b64 exec, s[92:93]
    ds_read_b128 v[112:115], v18 offset:20480
    ds_read_b128 v[116:119], v18 offset:20992
    s_mov_b64 exec, -1
    v_exp_f32 v70, v70
    v_exp_f32 v71, v71
    v_cvt_pk_bf16_f32 v96, v64, v65
    v_cvt_pk_bf16_f32 v97, v66, v67
    v_cvt_pk_bf16_f32 v98, v68, v69
    v_cvt_pk_bf16_f32 v99, v70, v71
    v_exp_f32 v72, v72
    v_exp_f32 v73, v73
    v_exp_f32 v74, v74
    s_waitcnt lgkmcnt(3)
    v_mfma_f32_32x32x16_bf16 v[80:95], v[120:123], v[96:99], v[80:95]
    v_exp_f32 v75, v75
    v_exp_f32 v76, v76
    v_exp_f32 v77, v77
    v_exp_f32 v78, v78
    v_exp_f32 v79, v79
    v_cvt_pk_bf16_f32 v100, v72, v73
    v_cvt_pk_bf16_f32 v101, v74, v75
    v_cvt_pk_bf16_f32 v102, v76, v77
    v_cvt_pk_bf16_f32 v103, v78, v79
    s_setprio 0
    v_mfma_f32_32x32x16_bf16 v[64:79], v[108:111], v[4:7], v[32:47]
    ds_read_b128 v[108:111], v17 offset:23552
    v_exp_f32 v48, v48
    v_exp_f32 v49, v49
    v_exp_f32 v50, v50
    v_exp_f32 v51, v51
    v_exp_f32 v52, v52
    v_exp_f32 v53, v53
    v_mfma_f32_32x32x16_bf16 v[80:95], v[124:127], v[100:103], v[80:95]
    s_mov_b64 exec, s[92:93]
    ds_read_b128 v[120:123], v18 offset:21504
    ds_read_b128 v[124:127], v18 offset:22016
    s_mov_b64 exec, -1
    v_exp_f32 v54, v54
    v_exp_f32 v55, v55
    v_cvt_pk_bf16_f32 v96, v48, v49
    v_cvt_pk_bf16_f32 v97, v50, v51
    v_cvt_pk_bf16_f32 v98, v52, v53
    v_cvt_pk_bf16_f32 v99, v54, v55
    v_exp_f32 v56, v56
    v_exp_f32 v57, v57
    v_exp_f32 v58, v58
    s_waitcnt lgkmcnt(3)
    v_mfma_f32_32x32x16_bf16 v[80:95], v[112:115], v[96:99], v[80:95]
    v_exp_f32 v59, v59
    v_exp_f32 v60, v60
    v_exp_f32 v61, v61
    v_exp_f32 v62, v62
    v_exp_f32 v63, v63
    v_cvt_pk_bf16_f32 v100, v56, v57
    v_cvt_pk_bf16_f32 v101, v58, v59
    v_cvt_pk_bf16_f32 v102, v60, v61
    v_cvt_pk_bf16_f32 v103, v62, v63
    s_barrier
    s_setprio 2
    v_mfma_f32_32x32x16_bf16 v[48:63], v[104:107], v[4:7], v[32:47]
    ds_read_b128 v[104:107], v17 offset:32768
    v_exp_f32 v64, v64
    v_exp_f32 v65, v65
    v_exp_f32 v66, v66
    v_exp_f32 v67, v67
    v_exp_f32 v68, v68
    v_exp_f32 v69, v69
    v_mfma_f32_32x32x16_bf16 v[80:95], v[116:119], v[100:103], v[80:95]
    s_mov_b64 exec, s[92:93]
    ds_read_b128 v[112:115], v18 offset:22528
    ds_read_b128 v[116:119], v18 offset:23040
    s_mov_b64 exec, -1
    v_exp_f32 v70, v70
    v_exp_f32 v71, v71
    v_cvt_pk_bf16_f32 v96, v64, v65
    v_cvt_pk_bf16_f32 v97, v66, v67
    v_cvt_pk_bf16_f32 v98, v68, v69
    v_cvt_pk_bf16_f32 v99, v70, v71
    v_exp_f32 v72, v72
    v_exp_f32 v73, v73
    v_exp_f32 v74, v74
    s_waitcnt lgkmcnt(3)
    v_mfma_f32_32x32x16_bf16 v[80:95], v[120:123], v[96:99], v[80:95]
    v_exp_f32 v75, v75
    v_exp_f32 v76, v76
    v_exp_f32 v77, v77
    v_exp_f32 v78, v78
    v_exp_f32 v79, v79
    v_cvt_pk_bf16_f32 v100, v72, v73
    v_cvt_pk_bf16_f32 v101, v74, v75
    v_cvt_pk_bf16_f32 v102, v76, v77
    v_cvt_pk_bf16_f32 v103, v78, v79
    v_mfma_f32_32x32x16_bf16 v[64:79], v[108:111], v[4:7], v[32:47]
    ds_read_b128 v[108:111], v17 offset:33792
    v_exp_f32 v48, v48
    v_exp_f32 v49, v49
    v_exp_f32 v50, v50
    v_exp_f32 v51, v51
    v_exp_f32 v52, v52
    v_exp_f32 v53, v53
    v_mfma_f32_32x32x16_bf16 v[80:95], v[124:127], v[100:103], v[80:95]
    s_mov_b64 exec, s[92:93]
    ds_read_b128 v[120:123], v18 offset:23552
    ds_read_b128 v[124:127], v18 offset:24064
    s_mov_b64 exec, -1
    v_exp_f32 v54, v54
    v_exp_f32 v55, v55
    v_cvt_pk_bf16_f32 v96, v48, v49
    v_cvt_pk_bf16_f32 v97, v50, v51
    v_cvt_pk_bf16_f32 v98, v52, v53
    v_cvt_pk_bf16_f32 v99, v54, v55
    v_exp_f32 v56, v56
    v_exp_f32 v57, v57
    v_exp_f32 v58, v58
    s_waitcnt lgkmcnt(3)
    v_mfma_f32_32x32x16_bf16 v[80:95], v[112:115], v[96:99], v[80:95]
    v_exp_f32 v59, v59
    v_exp_f32 v60, v60
    v_exp_f32 v61, v61
    v_exp_f32 v62, v62
    v_exp_f32 v63, v63
    v_cvt_pk_bf16_f32 v100, v56, v57
    v_cvt_pk_bf16_f32 v101, v58, v59
    v_cvt_pk_bf16_f32 v102, v60, v61
    v_cvt_pk_bf16_f32 v103, v62, v63
    v_mfma_f32_32x32x16_bf16 v[48:63], v[104:107], v[4:7], v[32:47]
    ds_read_b128 v[104:107], v17 offset:34816
    v_exp_f32 v64, v64
    v_exp_f32 v65, v65
    v_exp_f32 v66, v66
    v_exp_f32 v67, v67
    v_exp_f32 v68, v68
    v_exp_f32 v69, v69
    v_mfma_f32_32x32x16_bf16 v[80:95], v[116:119], v[100:103], v[80:95]
    s_mov_b64 exec, s[92:93]
    ds_read_b128 v[112:115], v18 offset:32768
    ds_read_b128 v[116:119], v18 offset:33280
    s_mov_b64 exec, -1
    v_exp_f32 v70, v70
    v_exp_f32 v71, v71
    v_cvt_pk_bf16_f32 v96, v64, v65
    v_cvt_pk_bf16_f32 v97, v66, v67
    v_cvt_pk_bf16_f32 v98, v68, v69
    v_cvt_pk_bf16_f32 v99, v70, v71
    v_exp_f32 v72, v72
    v_exp_f32 v73, v73
    v_exp_f32 v74, v74
    s_waitcnt lgkmcnt(3)
    v_mfma_f32_32x32x16_bf16 v[80:95], v[120:123], v[96:99], v[80:95]
    v_exp_f32 v75, v75
    v_exp_f32 v76, v76
    v_exp_f32 v77, v77
    v_exp_f32 v78, v78
    v_exp_f32 v79, v79
    v_cvt_pk_bf16_f32 v100, v72, v73
    v_cvt_pk_bf16_f32 v101, v74, v75
    v_cvt_pk_bf16_f32 v102, v76, v77
    v_cvt_pk_bf16_f32 v103, v78, v79
    v_mfma_f32_32x32x16_bf16 v[64:79], v[108:111], v[4:7], v[32:47]
    ds_read_b128 v[108:111], v17 offset:35840
    v_exp_f32 v48, v48
    v_exp_f32 v49, v49
    v_exp_f32 v50, v50
    v_exp_f32 v51, v51
    v_exp_f32 v52, v52
    v_exp_f32 v53, v53
    v_mfma_f32_32x32x16_bf16 v[80:95], v[124:127], v[100:103], v[80:95]
    s_mov_b64 exec, s[92:93]
    ds_read_b128 v[120:123], v18 offset:33792
    ds_read_b128 v[124:127], v18 offset:34304
    s_mov_b64 exec, -1
    v_exp_f32 v54, v54
    v_exp_f32 v55, v55
    v_cvt_pk_bf16_f32 v96, v48, v49
    v_cvt_pk_bf16_f32 v97, v50, v51
    v_cvt_pk_bf16_f32 v98, v52, v53
    v_cvt_pk_bf16_f32 v99, v54, v55
    v_exp_f32 v56, v56
    v_exp_f32 v57, v57
    v_exp_f32 v58, v58
    s_waitcnt lgkmcnt(3)
    v_mfma_f32_32x32x16_bf16 v[80:95], v[112:115], v[96:99], v[80:95]
    v_exp_f32 v59, v59
    v_exp_f32 v60, v60
    v_exp_f32 v61, v61
    v_exp_f32 v62, v62
    v_exp_f32 v63, v63
    v_cvt_pk_bf16_f32 v100, v56, v57
    v_cvt_pk_bf16_f32 v101, v58, v59
    v_cvt_pk_bf16_f32 v102, v60, v61
    v_cvt_pk_bf16_f32 v103, v62, v63
    s_setprio 1
    v_mfma_f32_32x32x16_bf16 v[48:63], v[104:107], v[4:7], v[32:47]
    ds_read_b128 v[104:107], v17 offset:36864
    v_exp_f32 v64, v64
    v_exp_f32 v65, v65
    v_exp_f32 v66, v66
    v_exp_f32 v67, v67
    v_exp_f32 v68, v68
    v_exp_f32 v69, v69
    v_mfma_f32_32x32x16_bf16 v[80:95], v[116:119], v[100:103], v[80:95]
    s_mov_b64 exec, s[92:93]
    ds_read_b128 v[112:115], v18 offset:34816
    ds_read_b128 v[116:119], v18 offset:35328
    s_mov_b64 exec, -1
    v_exp_f32 v70, v70
    v_exp_f32 v71, v71
    v_cvt_pk_bf16_f32 v96, v64, v65
    v_cvt_pk_bf16_f32 v97, v66, v67
    v_cvt_pk_bf16_f32 v98, v68, v69
    v_cvt_pk_bf16_f32 v99, v70, v71
    v_exp_f32 v72, v72
    v_exp_f32 v73, v73
    v_exp_f32 v74, v74
    s_waitcnt lgkmcnt(3)
    v_mfma_f32_32x32x16_bf16 v[80:95], v[120:123], v[96:99], v[80:95]
    v_exp_f32 v75, v75
    v_exp_f32 v76, v76
    v_exp_f32 v77, v77
    v_exp_f32 v78, v78
    v_exp_f32 v79, v79
    v_cvt_pk_bf16_f32 v100, v72, v73
    v_cvt_pk_bf16_f32 v101, v74, v75
    v_cvt_pk_bf16_f32 v102, v76, v77
    v_cvt_pk_bf16_f32 v103, v78, v79
    v_mfma_f32_32x32x16_bf16 v[64:79], v[108:111], v[4:7], v[32:47]
    ds_read_b128 v[108:111], v17 offset:37888
    v_exp_f32 v48, v48
    v_exp_f32 v49, v49
    v_exp_f32 v50, v50
    v_exp_f32 v51, v51
    v_exp_f32 v52, v52
    v_exp_f32 v53, v53
    v_mfma_f32_32x32x16_bf16 v[80:95], v[124:127], v[100:103], v[80:95]
    s_mov_b64 exec, s[92:93]
    ds_read_b128 v[120:123], v18 offset:35840
    ds_read_b128 v[124:127], v18 offset:36352
    s_mov_b64 exec, -1
    v_exp_f32 v54, v54
    v_exp_f32 v55, v55
    v_cvt_pk_bf16_f32 v96, v48, v49
    v_cvt_pk_bf16_f32 v97, v50, v51
    v_cvt_pk_bf16_f32 v98, v52, v53
    v_cvt_pk_bf16_f32 v99, v54, v55
    v_exp_f32 v56, v56
    v_exp_f32 v57, v57
    v_exp_f32 v58, v58
    s_waitcnt lgkmcnt(3)
    v_mfma_f32_32x32x16_bf16 v[80:95], v[112:115], v[96:99], v[80:95]
    v_exp_f32 v59, v59
    v_exp_f32 v60, v60
    v_exp_f32 v61, v61
    v_exp_f32 v62, v62
    v_exp_f32 v63, v63
    v_cvt_pk_bf16_f32 v100, v56, v57
    v_cvt_pk_bf16_f32 v101, v58, v59
    v_cvt_pk_bf16_f32 v102, v60, v61
    v_cvt_pk_bf16_f32 v103, v62, v63
    v_mfma_f32_32x32x16_bf16 v[48:63], v[104:107], v[4:7], v[32:47]
    ds_read_b128 v[104:107], v17 offset:38912
    v_exp_f32 v64, v64
    v_exp_f32 v65, v65
    v_exp_f32 v66, v66
    v_exp_f32 v67, v67
    v_exp_f32 v68, v68
    v_exp_f32 v69, v69
    v_mfma_f32_32x32x16_bf16 v[80:95], v[116:119], v[100:103], v[80:95]
    s_mov_b64 exec, s[92:93]
    ds_read_b128 v[112:115], v18 offset:36864
    ds_read_b128 v[116:119], v18 offset:37376
    s_mov_b64 exec, -1
    v_exp_f32 v70, v70
    v_exp_f32 v71, v71
    v_cvt_pk_bf16_f32 v96, v64, v65
    v_cvt_pk_bf16_f32 v97, v66, v67
    v_cvt_pk_bf16_f32 v98, v68, v69
    v_cvt_pk_bf16_f32 v99, v70, v71
    v_exp_f32 v72, v72
    v_exp_f32 v73, v73
    v_exp_f32 v74, v74
    s_waitcnt lgkmcnt(3)
    v_mfma_f32_32x32x16_bf16 v[80:95], v[120:123], v[96:99], v[80:95]
    v_exp_f32 v75, v75
    v_exp_f32 v76, v76
    v_exp_f32 v77, v77
    v_exp_f32 v78, v78
    v_exp_f32 v79, v79
    v_cvt_pk_bf16_f32 v100, v72, v73
    v_cvt_pk_bf16_f32 v101, v74, v75
    v_cvt_pk_bf16_f32 v102, v76, v77
    v_cvt_pk_bf16_f32 v103, v78, v79
    s_setprio 0
    v_mfma_f32_32x32x16_bf16 v[64:79], v[108:111], v[4:7], v[32:47]
    ds_read_b128 v[108:111], v17 offset:39936
    v_exp_f32 v48, v48
    v_exp_f32 v49, v49
    v_exp_f32 v50, v50
    v_exp_f32 v51, v51
    v_exp_f32 v52, v52
    v_exp_f32 v53, v53
    v_mfma_f32_32x32x16_bf16 v[80:95], v[124:127], v[100:103], v[80:95]
    s_mov_b64 exec, s[92:93]
    ds_read_b128 v[120:123], v18 offset:37888
    ds_read_b128 v[124:127], v18 offset:38400
    s_mov_b64 exec, -1
    v_exp_f32 v54, v54
    v_exp_f32 v55, v55
    v_cvt_pk_bf16_f32 v96, v48, v49
    v_cvt_pk_bf16_f32 v97, v50, v51
    v_cvt_pk_bf16_f32 v98, v52, v53
    v_cvt_pk_bf16_f32 v99, v54, v55
    v_exp_f32 v56, v56
    v_exp_f32 v57, v57
    v_exp_f32 v58, v58
    s_waitcnt lgkmcnt(3)
    v_mfma_f32_32x32x16_bf16 v[80:95], v[112:115], v[96:99], v[80:95]
    v_exp_f32 v59, v59
    v_exp_f32 v60, v60
    v_exp_f32 v61, v61
    v_exp_f32 v62, v62
    v_exp_f32 v63, v63
    v_cvt_pk_bf16_f32 v100, v56, v57
    v_cvt_pk_bf16_f32 v101, v58, v59
    v_cvt_pk_bf16_f32 v102, v60, v61
    v_cvt_pk_bf16_f32 v103, v62, v63
    s_barrier
    s_setprio 2
    v_mfma_f32_32x32x16_bf16 v[48:63], v[104:107], v[4:7], v[32:47]
    ds_read_b128 v[104:107], v17 offset:0
    v_exp_f32 v64, v64
    v_exp_f32 v65, v65
    v_exp_f32 v66, v66
    v_exp_f32 v67, v67
    v_exp_f32 v68, v68
    v_exp_f32 v69, v69
    v_mfma_f32_32x32x16_bf16 v[80:95], v[116:119], v[100:103], v[80:95]
    s_mov_b64 exec, s[92:93]
    ds_read_b128 v[112:115], v18 offset:38912
    ds_read_b128 v[116:119], v18 offset:39424
    s_mov_b64 exec, -1
    v_exp_f32 v70, v70
    v_exp_f32 v71, v71
    v_cvt_pk_bf16_f32 v96, v64, v65
    v_cvt_pk_bf16_f32 v97, v66, v67
    v_cvt_pk_bf16_f32 v98, v68, v69
    v_cvt_pk_bf16_f32 v99, v70, v71
    v_exp_f32 v72, v72
    v_exp_f32 v73, v73
    v_exp_f32 v74, v74
    s_waitcnt lgkmcnt(3)
    v_mfma_f32_32x32x16_bf16 v[80:95], v[120:123], v[96:99], v[80:95]
    v_exp_f32 v75, v75
    v_exp_f32 v76, v76
    v_exp_f32 v77, v77
    v_exp_f32 v78, v78
    v_exp_f32 v79, v79
    v_cvt_pk_bf16_f32 v100, v72, v73
    v_cvt_pk_bf16_f32 v101, v74, v75
    v_cvt_pk_bf16_f32 v102, v76, v77
    v_cvt_pk_bf16_f32 v103, v78, v79
    v_mfma_f32_32x32x16_bf16 v[64:79], v[108:111], v[4:7], v[32:47]
    ds_read_b128 v[108:111], v17 offset:1024
    v_exp_f32 v48, v48
    v_exp_f32 v49, v49
    v_exp_f32 v50, v50
    v_exp_f32 v51, v51
    v_exp_f32 v52, v52
    v_exp_f32 v53, v53
    v_mfma_f32_32x32x16_bf16 v[80:95], v[124:127], v[100:103], v[80:95]
    s_mov_b64 exec, s[92:93]
    ds_read_b128 v[120:123], v18 offset:39936
    ds_read_b128 v[124:127], v18 offset:40448
    s_mov_b64 exec, -1
    v_exp_f32 v54, v54
    v_exp_f32 v55, v55
    v_cvt_pk_bf16_f32 v96, v48, v49
    v_cvt_pk_bf16_f32 v97, v50, v51
    v_cvt_pk_bf16_f32 v98, v52, v53
    v_cvt_pk_bf16_f32 v99, v54, v55
    v_exp_f32 v56, v56
    v_exp_f32 v57, v57
    v_exp_f32 v58, v58
    s_waitcnt lgkmcnt(3)
    v_mfma_f32_32x32x16_bf16 v[80:95], v[112:115], v[96:99], v[80:95]
    v_exp_f32 v59, v59
    v_exp_f32 v60, v60
    v_exp_f32 v61, v61
    v_exp_f32 v62, v62
    v_exp_f32 v63, v63
    v_cvt_pk_bf16_f32 v100, v56, v57
    v_cvt_pk_bf16_f32 v101, v58, v59
    v_cvt_pk_bf16_f32 v102, v60, v61
    v_cvt_pk_bf16_f32 v103, v62, v63
    v_mfma_f32_32x32x16_bf16 v[48:63], v[104:107], v[4:7], v[32:47]
    ds_read_b128 v[104:107], v17 offset:2048
    v_exp_f32 v64, v64
    v_exp_f32 v65, v65
    v_exp_f32 v66, v66
    v_exp_f32 v67, v67
    v_exp_f32 v68, v68
    v_exp_f32 v69, v69
    v_mfma_f32_32x32x16_bf16 v[80:95], v[116:119], v[100:103], v[80:95]
    s_mov_b64 exec, s[92:93]
    ds_read_b128 v[112:115], v18 offset:0
    ds_read_b128 v[116:119], v18 offset:512
    s_mov_b64 exec, -1
    v_exp_f32 v70, v70
    v_exp_f32 v71, v71
    v_cvt_pk_bf16_f32 v96, v64, v65
    v_cvt_pk_bf16_f32 v97, v66, v67
    v_cvt_pk_bf16_f32 v98, v68, v69
    v_cvt_pk_bf16_f32 v99, v70, v71
    v_exp_f32 v72, v72
    v_exp_f32 v73, v73
    v_exp_f32 v74, v74
    s_waitcnt lgkmcnt(3)
    v_mfma_f32_32x32x16_bf16 v[80:95], v[120:123], v[96:99], v[80:95]
    v_exp_f32 v75, v75
    v_exp_f32 v76, v76
    v_exp_f32 v77, v77
    v_exp_f32 v78, v78
    v_exp_f32 v79, v79
    v_cvt_pk_bf16_f32 v100, v72, v73
    v_cvt_pk_bf16_f32 v101, v74, v75
    v_cvt_pk_bf16_f32 v102, v76, v77
    v_cvt_pk_bf16_f32 v103, v78, v79
    v_mfma_f32_32x32x16_bf16 v[64:79], v[108:111], v[4:7], v[32:47]
    ds_read_b128 v[108:111], v17 offset:3072
    v_exp_f32 v48, v48
    v_exp_f32 v49, v49
    v_exp_f32 v50, v50
    v_exp_f32 v51, v51
    v_exp_f32 v52, v52
    v_exp_f32 v53, v53
    v_mfma_f32_32x32x16_bf16 v[80:95], v[124:127], v[100:103], v[80:95]
    s_mov_b64 exec, s[92:93]
    ds_read_b128 v[120:123], v18 offset:1024
    ds_read_b128 v[124:127], v18 offset:1536
    s_mov_b64 exec, -1
    v_exp_f32 v54, v54
    v_exp_f32 v55, v55
    v_cvt_pk_bf16_f32 v96, v48, v49
    v_cvt_pk_bf16_f32 v97, v50, v51
    v_cvt_pk_bf16_f32 v98, v52, v53
    v_cvt_pk_bf16_f32 v99, v54, v55
    v_exp_f32 v56, v56
    v_exp_f32 v57, v57
    v_exp_f32 v58, v58
    s_waitcnt lgkmcnt(3)
    v_mfma_f32_32x32x16_bf16 v[80:95], v[112:115], v[96:99], v[80:95]
    v_exp_f32 v59, v59
    v_exp_f32 v60, v60
    v_exp_f32 v61, v61
    v_exp_f32 v62, v62
    v_exp_f32 v63, v63
    v_cvt_pk_bf16_f32 v100, v56, v57
    v_cvt_pk_bf16_f32 v101, v58, v59
    v_cvt_pk_bf16_f32 v102, v60, v61
    v_cvt_pk_bf16_f32 v103, v62, v63
    s_setprio 1
    v_mfma_f32_32x32x16_bf16 v[48:63], v[104:107], v[4:7], v[32:47]
    ds_read_b128 v[104:107], v17 offset:4096
    v_exp_f32 v64, v64
    v_exp_f32 v65, v65
    v_exp_f32 v66, v66
    v_exp_f32 v67, v67
    v_exp_f32 v68, v68
    v_exp_f32 v69, v69
    v_mfma_f32_32x32x16_bf16 v[80:95], v[116:119], v[100:103], v[80:95]
    s_mov_b64 exec, s[92:93]
    ds_read_b128 v[112:115], v18 offset:2048
    ds_read_b128 v[116:119], v18 offset:2560
    s_mov_b64 exec, -1
    v_exp_f32 v70, v70
    v_exp_f32 v71, v71
    v_cvt_pk_bf16_f32 v96, v64, v65
    v_cvt_pk_bf16_f32 v97, v66, v67
    v_cvt_pk_bf16_f32 v98, v68, v69
    v_cvt_pk_bf16_f32 v99, v70, v71
    v_exp_f32 v72, v72
    v_exp_f32 v73, v73
    v_exp_f32 v74, v74
    s_waitcnt lgkmcnt(3)
    v_mfma_f32_32x32x16_bf16 v[80:95], v[120:123], v[96:99], v[80:95]
    v_exp_f32 v75, v75
    v_exp_f32 v76, v76
    v_exp_f32 v77, v77
    v_exp_f32 v78, v78
    v_exp_f32 v79, v79
    v_cvt_pk_bf16_f32 v100, v72, v73
    v_cvt_pk_bf16_f32 v101, v74, v75
    v_cvt_pk_bf16_f32 v102, v76, v77
    v_cvt_pk_bf16_f32 v103, v78, v79
    v_mfma_f32_32x32x16_bf16 v[64:79], v[108:111], v[4:7], v[32:47]
    ds_read_b128 v[108:111], v17 offset:5120
    v_exp_f32 v48, v48
    v_exp_f32 v49, v49
    v_exp_f32 v50, v50
    v_exp_f32 v51, v51
    v_exp_f32 v52, v52
    v_exp_f32 v53, v53
    v_mfma_f32_32x32x16_bf16 v[80:95], v[124:127], v[100:103], v[80:95]
    s_mov_b64 exec, s[92:93]
    ds_read_b128 v[120:123], v18 offset:3072
    ds_read_b128 v[124:127], v18 offset:3584
    s_mov_b64 exec, -1
    v_exp_f32 v54, v54
    v_exp_f32 v55, v55
    v_cvt_pk_bf16_f32 v96, v48, v49
    v_cvt_pk_bf16_f32 v97, v50, v51
    v_cvt_pk_bf16_f32 v98, v52, v53
    v_cvt_pk_bf16_f32 v99, v54, v55
    v_exp_f32 v56, v56
    v_exp_f32 v57, v57
    v_exp_f32 v58, v58
    s_waitcnt lgkmcnt(3)
    v_mfma_f32_32x32x16_bf16 v[80:95], v[112:115], v[96:99], v[80:95]
    v_exp_f32 v59, v59
    v_exp_f32 v60, v60
    v_exp_f32 v61, v61
    v_exp_f32 v62, v62
    v_exp_f32 v63, v63
    v_cvt_pk_bf16_f32 v100, v56, v57
    v_cvt_pk_bf16_f32 v101, v58, v59
    v_cvt_pk_bf16_f32 v102, v60, v61
    v_cvt_pk_bf16_f32 v103, v62, v63
    v_mfma_f32_32x32x16_bf16 v[48:63], v[104:107], v[4:7], v[32:47]
    ds_read_b128 v[104:107], v17 offset:6144
    v_exp_f32 v64, v64
    v_exp_f32 v65, v65
    v_exp_f32 v66, v66
    v_exp_f32 v67, v67
    v_exp_f32 v68, v68
    v_exp_f32 v69, v69
    v_mfma_f32_32x32x16_bf16 v[80:95], v[116:119], v[100:103], v[80:95]
    s_mov_b64 exec, s[92:93]
    ds_read_b128 v[112:115], v18 offset:4096
    ds_read_b128 v[116:119], v18 offset:4608
    s_mov_b64 exec, -1
    v_exp_f32 v70, v70
    v_exp_f32 v71, v71
    v_cvt_pk_bf16_f32 v96, v64, v65
    v_cvt_pk_bf16_f32 v97, v66, v67
    v_cvt_pk_bf16_f32 v98, v68, v69
    v_cvt_pk_bf16_f32 v99, v70, v71
    v_exp_f32 v72, v72
    v_exp_f32 v73, v73
    v_exp_f32 v74, v74
    s_waitcnt lgkmcnt(3)
    v_mfma_f32_32x32x16_bf16 v[80:95], v[120:123], v[96:99], v[80:95]
    v_exp_f32 v75, v75
    v_exp_f32 v76, v76
    v_exp_f32 v77, v77
    v_exp_f32 v78, v78
    v_exp_f32 v79, v79
    v_cvt_pk_bf16_f32 v100, v72, v73
    v_cvt_pk_bf16_f32 v101, v74, v75
    v_cvt_pk_bf16_f32 v102, v76, v77
    v_cvt_pk_bf16_f32 v103, v78, v79
    s_setprio 0
    v_mfma_f32_32x32x16_bf16 v[64:79], v[108:111], v[4:7], v[32:47]
    ds_read_b128 v[108:111], v17 offset:7168
    v_exp_f32 v48, v48
    v_exp_f32 v49, v49
    v_exp_f32 v50, v50
    v_exp_f32 v51, v51
    v_exp_f32 v52, v52
    v_exp_f32 v53, v53
    v_mfma_f32_32x32x16_bf16 v[80:95], v[124:127], v[100:103], v[80:95]
    s_mov_b64 exec, s[92:93]
    ds_read_b128 v[120:123], v18 offset:5120
    ds_read_b128 v[124:127], v18 offset:5632
    s_mov_b64 exec, -1
    v_exp_f32 v54, v54
    v_exp_f32 v55, v55
    v_cvt_pk_bf16_f32 v96, v48, v49
    v_cvt_pk_bf16_f32 v97, v50, v51
    v_cvt_pk_bf16_f32 v98, v52, v53
    v_cvt_pk_bf16_f32 v99, v54, v55
    v_exp_f32 v56, v56
    v_exp_f32 v57, v57
    v_exp_f32 v58, v58
    s_waitcnt lgkmcnt(3)
    v_mfma_f32_32x32x16_bf16 v[80:95], v[112:115], v[96:99], v[80:95]
    v_exp_f32 v59, v59
    v_exp_f32 v60, v60
    v_exp_f32 v61, v61
    v_exp_f32 v62, v62
    v_exp_f32 v63, v63
    v_cvt_pk_bf16_f32 v100, v56, v57
    v_cvt_pk_bf16_f32 v101, v58, v59
    v_cvt_pk_bf16_f32 v102, v60, v61
    v_cvt_pk_bf16_f32 v103, v62, v63
    s_barrier
    s_setprio 2
    v_mfma_f32_32x32x16_bf16 v[48:63], v[104:107], v[4:7], v[32:47]
    ds_read_b128 v[104:107], v17 offset:16384
    v_exp_f32 v64, v64
    v_exp_f32 v65, v65
    v_exp_f32 v66, v66
    v_exp_f32 v67, v67
    v_exp_f32 v68, v68
    v_exp_f32 v69, v69
    v_mfma_f32_32x32x16_bf16 v[80:95], v[116:119], v[100:103], v[80:95]
    s_mov_b64 exec, s[92:93]
    ds_read_b128 v[112:115], v18 offset:6144
    ds_read_b128 v[116:119], v18 offset:6656
    s_mov_b64 exec, -1
    v_exp_f32 v70, v70
    v_exp_f32 v71, v71
    v_cvt_pk_bf16_f32 v96, v64, v65
    v_cvt_pk_bf16_f32 v97, v66, v67
    v_cvt_pk_bf16_f32 v98, v68, v69
    v_cvt_pk_bf16_f32 v99, v70, v71
    v_exp_f32 v72, v72
    v_exp_f32 v73, v73
    v_exp_f32 v74, v74
    s_waitcnt lgkmcnt(3)
    v_mfma_f32_32x32x16_bf16 v[80:95], v[120:123], v[96:99], v[80:95]
    v_exp_f32 v75, v75
    v_exp_f32 v76, v76
    v_exp_f32 v77, v77
    v_exp_f32 v78, v78
    v_exp_f32 v79, v79
    v_cvt_pk_bf16_f32 v100, v72, v73
    v_cvt_pk_bf16_f32 v101, v74, v75
    v_cvt_pk_bf16_f32 v102, v76, v77
    v_cvt_pk_bf16_f32 v103, v78, v79
    v_mfma_f32_32x32x16_bf16 v[64:79], v[108:111], v[4:7], v[32:47]
    ds_read_b128 v[108:111], v17 offset:17408
    v_exp_f32 v48, v48
    v_exp_f32 v49, v49
    v_exp_f32 v50, v50
    v_exp_f32 v51, v51
    v_exp_f32 v52, v52
    v_exp_f32 v53, v53
    v_mfma_f32_32x32x16_bf16 v[80:95], v[124:127], v[100:103], v[80:95]
    s_mov_b64 exec, s[92:93]
    ds_read_b128 v[120:123], v18 offset:7168
    ds_read_b128 v[124:127], v18 offset:7680
    s_mov_b64 exec, -1
    v_exp_f32 v54, v54
    v_exp_f32 v55, v55
    v_cvt_pk_bf16_f32 v96, v48, v49
    v_cvt_pk_bf16_f32 v97, v50, v51
    v_cvt_pk_bf16_f32 v98, v52, v53
    v_cvt_pk_bf16_f32 v99, v54, v55
    v_exp_f32 v56, v56
    v_exp_f32 v57, v57
    v_exp_f32 v58, v58
    s_waitcnt lgkmcnt(3)
    v_mfma_f32_32x32x16_bf16 v[80:95], v[112:115], v[96:99], v[80:95]
    v_exp_f32 v59, v59
    v_exp_f32 v60, v60
    v_exp_f32 v61, v61
    v_exp_f32 v62, v62
    v_exp_f32 v63, v63
    v_cvt_pk_bf16_f32 v100, v56, v57
    v_cvt_pk_bf16_f32 v101, v58, v59
    v_cvt_pk_bf16_f32 v102, v60, v61
    v_cvt_pk_bf16_f32 v103, v62, v63
    v_mfma_f32_32x32x16_bf16 v[48:63], v[104:107], v[4:7], v[32:47]
    ds_read_b128 v[104:107], v17 offset:18432
    v_exp_f32 v64, v64
    v_exp_f32 v65, v65
    v_exp_f32 v66, v66
    v_exp_f32 v67, v67
    v_exp_f32 v68, v68
    v_exp_f32 v69, v69
    v_mfma_f32_32x32x16_bf16 v[80:95], v[116:119], v[100:103], v[80:95]
    s_mov_b64 exec, s[92:93]
    ds_read_b128 v[112:115], v18 offset:16384
    ds_read_b128 v[116:119], v18 offset:16896
    s_mov_b64 exec, -1
    v_exp_f32 v70, v70
    v_exp_f32 v71, v71
    v_cvt_pk_bf16_f32 v96, v64, v65
    v_cvt_pk_bf16_f32 v97, v66, v67
    v_cvt_pk_bf16_f32 v98, v68, v69
    v_cvt_pk_bf16_f32 v99, v70, v71
    v_exp_f32 v72, v72
    v_exp_f32 v73, v73
    v_exp_f32 v74, v74
    s_waitcnt lgkmcnt(3)
    v_mfma_f32_32x32x16_bf16 v[80:95], v[120:123], v[96:99], v[80:95]
    v_exp_f32 v75, v75
    v_exp_f32 v76, v76
    v_exp_f32 v77, v77
    v_exp_f32 v78, v78
    v_exp_f32 v79, v79
    v_cvt_pk_bf16_f32 v100, v72, v73
    v_cvt_pk_bf16_f32 v101, v74, v75
    v_cvt_pk_bf16_f32 v102, v76, v77
    v_cvt_pk_bf16_f32 v103, v78, v79
    v_mfma_f32_32x32x16_bf16 v[64:79], v[108:111], v[4:7], v[32:47]
    ds_read_b128 v[108:111], v17 offset:19456
    v_exp_f32 v48, v48
    v_exp_f32 v49, v49
    v_exp_f32 v50, v50
    v_exp_f32 v51, v51
    v_exp_f32 v52, v52
    v_exp_f32 v53, v53
    v_mfma_f32_32x32x16_bf16 v[80:95], v[124:127], v[100:103], v[80:95]
    s_mov_b64 exec, s[92:93]
    ds_read_b128 v[120:123], v18 offset:17408
    ds_read_b128 v[124:127], v18 offset:17920
    s_mov_b64 exec, -1
    v_exp_f32 v54, v54
    v_exp_f32 v55, v55
    v_cvt_pk_bf16_f32 v96, v48, v49
    v_cvt_pk_bf16_f32 v97, v50, v51
    v_cvt_pk_bf16_f32 v98, v52, v53
    v_cvt_pk_bf16_f32 v99, v54, v55
    v_exp_f32 v56, v56
    v_exp_f32 v57, v57
    v_exp_f32 v58, v58
    s_waitcnt lgkmcnt(3)
    v_mfma_f32_32x32x16_bf16 v[80:95], v[112:115], v[96:99], v[80:95]
    v_exp_f32 v59, v59
    v_exp_f32 v60, v60
    v_exp_f32 v61, v61
    v_exp_f32 v62, v62
    v_exp_f32 v63, v63
    v_cvt_pk_bf16_f32 v100, v56, v57
    v_cvt_pk_bf16_f32 v101, v58, v59
    v_cvt_pk_bf16_f32 v102, v60, v61
    v_cvt_pk_bf16_f32 v103, v62, v63
    s_setprio 1
    v_mfma_f32_32x32x16_bf16 v[48:63], v[104:107], v[4:7], v[32:47]
    ds_read_b128 v[104:107], v17 offset:20480
    v_exp_f32 v64, v64
    v_exp_f32 v65, v65
    v_exp_f32 v66, v66
    v_exp_f32 v67, v67
    v_exp_f32 v68, v68
    v_exp_f32 v69, v69
    v_mfma_f32_32x32x16_bf16 v[80:95], v[116:119], v[100:103], v[80:95]
    s_mov_b64 exec, s[92:93]
    ds_read_b128 v[112:115], v18 offset:18432
    ds_read_b128 v[116:119], v18 offset:18944
    s_mov_b64 exec, -1
    v_exp_f32 v70, v70
    v_exp_f32 v71, v71
    v_cvt_pk_bf16_f32 v96, v64, v65
    v_cvt_pk_bf16_f32 v97, v66, v67
    v_cvt_pk_bf16_f32 v98, v68, v69
    v_cvt_pk_bf16_f32 v99, v70, v71
    v_exp_f32 v72, v72
    v_exp_f32 v73, v73
    v_exp_f32 v74, v74
    s_waitcnt lgkmcnt(3)
    v_mfma_f32_32x32x16_bf16 v[80:95], v[120:123], v[96:99], v[80:95]
    v_exp_f32 v75, v75
    v_exp_f32 v76, v76
    v_exp_f32 v77, v77
    v_exp_f32 v78, v78
    v_exp_f32 v79, v79
    v_cvt_pk_bf16_f32 v100, v72, v73
    v_cvt_pk_bf16_f32 v101, v74, v75
    v_cvt_pk_bf16_f32 v102, v76, v77
    v_cvt_pk_bf16_f32 v103, v78, v79
    v_mfma_f32_32x32x16_bf16 v[64:79], v[108:111], v[4:7], v[32:47]
    ds_read_b128 v[108:111], v17 offset:21504
    v_exp_f32 v48, v48
    v_exp_f32 v49, v49
    v_exp_f32 v50, v50
    v_exp_f32 v51, v51
    v_exp_f32 v52, v52
    v_exp_f32 v53, v53
    v_mfma_f32_32x32x16_bf16 v[80:95], v[124:127], v[100:103], v[80:95]
    s_mov_b64 exec, s[92:93]
    ds_read_b128 v[120:123], v18 offset:19456
    ds_read_b128 v[124:127], v18 offset:19968
    s_mov_b64 exec, -1
    v_exp_f32 v54, v54
    v_exp_f32 v55, v55
    v_cvt_pk_bf16_f32 v96, v48, v49
    v_cvt_pk_bf16_f32 v97, v50, v51
    v_cvt_pk_bf16_f32 v98, v52, v53
    v_cvt_pk_bf16_f32 v99, v54, v55
    v_exp_f32 v56, v56
    v_exp_f32 v57, v57
    v_exp_f32 v58, v58
    s_waitcnt lgkmcnt(3)
    v_mfma_f32_32x32x16_bf16 v[80:95], v[112:115], v[96:99], v[80:95]
    v_exp_f32 v59, v59
    v_exp_f32 v60, v60
    v_exp_f32 v61, v61
    v_exp_f32 v62, v62
    v_exp_f32 v63, v63
    v_cvt_pk_bf16_f32 v100, v56, v57
    v_cvt_pk_bf16_f32 v101, v58, v59
    v_cvt_pk_bf16_f32 v102, v60, v61
    v_cvt_pk_bf16_f32 v103, v62, v63
    v_mfma_f32_32x32x16_bf16 v[48:63], v[104:107], v[4:7], v[32:47]
    ds_read_b128 v[104:107], v17 offset:22528
    v_exp_f32 v64, v64
    v_exp_f32 v65, v65
    v_exp_f32 v66, v66
    v_exp_f32 v67, v67
    v_exp_f32 v68, v68
    v_exp_f32 v69, v69
    v_mfma_f32_32x32x16_bf16 v[80:95], v[116:119], v[100:103], v[80:95]
    s_mov_b64 exec, s[92:93]
    ds_read_b128 v[112:115], v18 offset:20480
    ds_read_b128 v[116:119], v18 offset:20992
    s_mov_b64 exec, -1
    v_exp_f32 v70, v70
    v_exp_f32 v71, v71
    v_cvt_pk_bf16_f32 v96, v64, v65
    v_cvt_pk_bf16_f32 v97, v66, v67
    v_cvt_pk_bf16_f32 v98, v68, v69
    v_cvt_pk_bf16_f32 v99, v70, v71
    v_exp_f32 v72, v72
    v_exp_f32 v73, v73
    v_exp_f32 v74, v74
    s_waitcnt lgkmcnt(3)
    v_mfma_f32_32x32x16_bf16 v[80:95], v[120:123], v[96:99], v[80:95]
    v_exp_f32 v75, v75
    v_exp_f32 v76, v76
    v_exp_f32 v77, v77
    v_exp_f32 v78, v78
    v_exp_f32 v79, v79
    v_cvt_pk_bf16_f32 v100, v72, v73
    v_cvt_pk_bf16_f32 v101, v74, v75
    v_cvt_pk_bf16_f32 v102, v76, v77
    v_cvt_pk_bf16_f32 v103, v78, v79
    s_setprio 0
    v_mfma_f32_32x32x16_bf16 v[64:79], v[108:111], v[4:7], v[32:47]
    ds_read_b128 v[108:111], v17 offset:23552
    v_exp_f32 v48, v48
    v_exp_f32 v49, v49
    v_exp_f32 v50, v50
    v_exp_f32 v51, v51
    v_exp_f32 v52, v52
    v_exp_f32 v53, v53
    v_mfma_f32_32x32x16_bf16 v[80:95], v[124:127], v[100:103], v[80:95]
    s_mov_b64 exec, s[92:93]
    ds_read_b128 v[120:123], v18 offset:21504
    ds_read_b128 v[124:127], v18 offset:22016
    s_mov_b64 exec, -1
    v_exp_f32 v54, v54
    v_exp_f32 v55, v55
    v_cvt_pk_bf16_f32 v96, v48, v49
    v_cvt_pk_bf16_f32 v97, v50, v51
    v_cvt_pk_bf16_f32 v98, v52, v53
    v_cvt_pk_bf16_f32 v99, v54, v55
    v_exp_f32 v56, v56
    v_exp_f32 v57, v57
    v_exp_f32 v58, v58
    s_waitcnt lgkmcnt(3)
    v_mfma_f32_32x32x16_bf16 v[80:95], v[112:115], v[96:99], v[80:95]
    v_exp_f32 v59, v59
    v_exp_f32 v60, v60
    v_exp_f32 v61, v61
    v_exp_f32 v62, v62
    v_exp_f32 v63, v63
    v_cvt_pk_bf16_f32 v100, v56, v57
    v_cvt_pk_bf16_f32 v101, v58, v59
    v_cvt_pk_bf16_f32 v102, v60, v61
    v_cvt_pk_bf16_f32 v103, v62, v63
    s_barrier
    s_setprio 2
    v_mfma_f32_32x32x16_bf16 v[48:63], v[104:107], v[4:7], v[32:47]
    ds_read_b128 v[104:107], v17 offset:32768
    v_exp_f32 v64, v64
    v_exp_f32 v65, v65
    v_exp_f32 v66, v66
    v_exp_f32 v67, v67
    v_exp_f32 v68, v68
    v_exp_f32 v69, v69
    v_mfma_f32_32x32x16_bf16 v[80:95], v[116:119], v[100:103], v[80:95]
    s_mov_b64 exec, s[92:93]
    ds_read_b128 v[112:115], v18 offset:22528
    ds_read_b128 v[116:119], v18 offset:23040
    s_mov_b64 exec, -1
    v_exp_f32 v70, v70
    v_exp_f32 v71, v71
    v_cvt_pk_bf16_f32 v96, v64, v65
    v_cvt_pk_bf16_f32 v97, v66, v67
    v_cvt_pk_bf16_f32 v98, v68, v69
    v_cvt_pk_bf16_f32 v99, v70, v71
    v_exp_f32 v72, v72
    v_exp_f32 v73, v73
    v_exp_f32 v74, v74
    s_waitcnt lgkmcnt(3)
    v_mfma_f32_32x32x16_bf16 v[80:95], v[120:123], v[96:99], v[80:95]
    v_exp_f32 v75, v75
    v_exp_f32 v76, v76
    v_exp_f32 v77, v77
    v_exp_f32 v78, v78
    v_exp_f32 v79, v79
    v_cvt_pk_bf16_f32 v100, v72, v73
    v_cvt_pk_bf16_f32 v101, v74, v75
    v_cvt_pk_bf16_f32 v102, v76, v77
    v_cvt_pk_bf16_f32 v103, v78, v79
    v_mfma_f32_32x32x16_bf16 v[64:79], v[108:111], v[4:7], v[32:47]
    ds_read_b128 v[108:111], v17 offset:33792
    v_exp_f32 v48, v48
    v_exp_f32 v49, v49
    v_exp_f32 v50, v50
    v_exp_f32 v51, v51
    v_exp_f32 v52, v52
    v_exp_f32 v53, v53
    v_mfma_f32_32x32x16_bf16 v[80:95], v[124:127], v[100:103], v[80:95]
    s_mov_b64 exec, s[92:93]
    ds_read_b128 v[120:123], v18 offset:23552
    ds_read_b128 v[124:127], v18 offset:24064
    s_mov_b64 exec, -1
    v_exp_f32 v54, v54
    v_exp_f32 v55, v55
    v_cvt_pk_bf16_f32 v96, v48, v49
    v_cvt_pk_bf16_f32 v97, v50, v51
    v_cvt_pk_bf16_f32 v98, v52, v53
    v_cvt_pk_bf16_f32 v99, v54, v55
    v_exp_f32 v56, v56
    v_exp_f32 v57, v57
    v_exp_f32 v58, v58
    s_waitcnt lgkmcnt(3)
    v_mfma_f32_32x32x16_bf16 v[80:95], v[112:115], v[96:99], v[80:95]
    v_exp_f32 v59, v59
    v_exp_f32 v60, v60
    v_exp_f32 v61, v61
    v_exp_f32 v62, v62
    v_exp_f32 v63, v63
    v_cvt_pk_bf16_f32 v100, v56, v57
    v_cvt_pk_bf16_f32 v101, v58, v59
    v_cvt_pk_bf16_f32 v102, v60, v61
    v_cvt_pk_bf16_f32 v103, v62, v63
    v_mfma_f32_32x32x16_bf16 v[48:63], v[104:107], v[4:7], v[32:47]
    ds_read_b128 v[104:107], v17 offset:34816
    v_exp_f32 v64, v64
    v_exp_f32 v65, v65
    v_exp_f32 v66, v66
    v_exp_f32 v67, v67
    v_exp_f32 v68, v68
    v_exp_f32 v69, v69
    v_mfma_f32_32x32x16_bf16 v[80:95], v[116:119], v[100:103], v[80:95]
    s_mov_b64 exec, s[92:93]
    ds_read_b128 v[112:115], v18 offset:32768
    ds_read_b128 v[116:119], v18 offset:33280
    s_mov_b64 exec, -1
    v_exp_f32 v70, v70
    v_exp_f32 v71, v71
    v_cvt_pk_bf16_f32 v96, v64, v65
    v_cvt_pk_bf16_f32 v97, v66, v67
    v_cvt_pk_bf16_f32 v98, v68, v69
    v_cvt_pk_bf16_f32 v99, v70, v71
    v_exp_f32 v72, v72
    v_exp_f32 v73, v73
    v_exp_f32 v74, v74
    s_waitcnt lgkmcnt(3)
    v_mfma_f32_32x32x16_bf16 v[80:95], v[120:123], v[96:99], v[80:95]
    v_exp_f32 v75, v75
    v_exp_f32 v76, v76
    v_exp_f32 v77, v77
    v_exp_f32 v78, v78
    v_exp_f32 v79, v79
    v_cvt_pk_bf16_f32 v100, v72, v73
    v_cvt_pk_bf16_f32 v101, v74, v75
    v_cvt_pk_bf16_f32 v102, v76, v77
    v_cvt_pk_bf16_f32 v103, v78, v79
    v_mfma_f32_32x32x16_bf16 v[64:79], v[108:111], v[4:7], v[32:47]
    ds_read_b128 v[108:111], v17 offset:35840
    v_exp_f32 v48, v48
    v_exp_f32 v49, v49
    v_exp_f32 v50, v50
    v_exp_f32 v51, v51
    v_exp_f32 v52, v52
    v_exp_f32 v53, v53
    v_mfma_f32_32x32x16_bf16 v[80:95], v[124:127], v[100:103], v[80:95]
    s_mov_b64 exec, s[92:93]
    ds_read_b128 v[120:123], v18 offset:33792
    ds_read_b128 v[124:127], v18 offset:34304
    s_mov_b64 exec, -1
    v_exp_f32 v54, v54
    v_exp_f32 v55, v55
    v_cvt_pk_bf16_f32 v96, v48, v49
    v_cvt_pk_bf16_f32 v97, v50, v51
    v_cvt_pk_bf16_f32 v98, v52, v53
    v_cvt_pk_bf16_f32 v99, v54, v55
    v_exp_f32 v56, v56
    v_exp_f32 v57, v57
    v_exp_f32 v58, v58
    s_waitcnt lgkmcnt(3)
    v_mfma_f32_32x32x16_bf16 v[80:95], v[112:115], v[96:99], v[80:95]
    v_exp_f32 v59, v59
    v_exp_f32 v60, v60
    v_exp_f32 v61, v61
    v_exp_f32 v62, v62
    v_exp_f32 v63, v63
    v_cvt_pk_bf16_f32 v100, v56, v57
    v_cvt_pk_bf16_f32 v101, v58, v59
    v_cvt_pk_bf16_f32 v102, v60, v61
    v_cvt_pk_bf16_f32 v103, v62, v63
    s_setprio 1
    v_mfma_f32_32x32x16_bf16 v[48:63], v[104:107], v[4:7], v[32:47]
    ds_read_b128 v[104:107], v17 offset:36864
    v_exp_f32 v64, v64
    v_exp_f32 v65, v65
    v_exp_f32 v66, v66
    v_exp_f32 v67, v67
    v_exp_f32 v68, v68
    v_exp_f32 v69, v69
    v_mfma_f32_32x32x16_bf16 v[80:95], v[116:119], v[100:103], v[80:95]
    s_mov_b64 exec, s[92:93]
    ds_read_b128 v[112:115], v18 offset:34816
    ds_read_b128 v[116:119], v18 offset:35328
    s_mov_b64 exec, -1
    v_exp_f32 v70, v70
    v_exp_f32 v71, v71
    v_cvt_pk_bf16_f32 v96, v64, v65
    v_cvt_pk_bf16_f32 v97, v66, v67
    v_cvt_pk_bf16_f32 v98, v68, v69
    v_cvt_pk_bf16_f32 v99, v70, v71
    v_exp_f32 v72, v72
    v_exp_f32 v73, v73
    v_exp_f32 v74, v74
    s_waitcnt lgkmcnt(3)
    v_mfma_f32_32x32x16_bf16 v[80:95], v[120:123], v[96:99], v[80:95]
    v_exp_f32 v75, v75
    v_exp_f32 v76, v76
    v_exp_f32 v77, v77
    v_exp_f32 v78, v78
    v_exp_f32 v79, v79
    v_cvt_pk_bf16_f32 v100, v72, v73
    v_cvt_pk_bf16_f32 v101, v74, v75
    v_cvt_pk_bf16_f32 v102, v76, v77
    v_cvt_pk_bf16_f32 v103, v78, v79
    v_mfma_f32_32x32x16_bf16 v[64:79], v[108:111], v[4:7], v[32:47]
    ds_read_b128 v[108:111], v17 offset:37888
    v_exp_f32 v48, v48
    v_exp_f32 v49, v49
    v_exp_f32 v50, v50
    v_exp_f32 v51, v51
    v_exp_f32 v52, v52
    v_exp_f32 v53, v53
    v_mfma_f32_32x32x16_bf16 v[80:95], v[124:127], v[100:103], v[80:95]
    s_mov_b64 exec, s[92:93]
    ds_read_b128 v[120:123], v18 offset:35840
    ds_read_b128 v[124:127], v18 offset:36352
    s_mov_b64 exec, -1
    v_exp_f32 v54, v54
    v_exp_f32 v55, v55
    v_cvt_pk_bf16_f32 v96, v48, v49
    v_cvt_pk_bf16_f32 v97, v50, v51
    v_cvt_pk_bf16_f32 v98, v52, v53
    v_cvt_pk_bf16_f32 v99, v54, v55
    v_exp_f32 v56, v56
    v_exp_f32 v57, v57
    v_exp_f32 v58, v58
    s_waitcnt lgkmcnt(3)
    v_mfma_f32_32x32x16_bf16 v[80:95], v[112:115], v[96:99], v[80:95]
    v_exp_f32 v59, v59
    v_exp_f32 v60, v60
    v_exp_f32 v61, v61
    v_exp_f32 v62, v62
    v_exp_f32 v63, v63
    v_cvt_pk_bf16_f32 v100, v56, v57
    v_cvt_pk_bf16_f32 v101, v58, v59
    v_cvt_pk_bf16_f32 v102, v60, v61
    v_cvt_pk_bf16_f32 v103, v62, v63
    v_mfma_f32_32x32x16_bf16 v[48:63], v[104:107], v[4:7], v[32:47]
    ds_read_b128 v[104:107], v17 offset:38912
    v_exp_f32 v64, v64
    v_exp_f32 v65, v65
    v_exp_f32 v66, v66
    v_exp_f32 v67, v67
    v_exp_f32 v68, v68
    v_exp_f32 v69, v69
    v_mfma_f32_32x32x16_bf16 v[80:95], v[116:119], v[100:103], v[80:95]
    s_mov_b64 exec, s[92:93]
    ds_read_b128 v[112:115], v18 offset:36864
    ds_read_b128 v[116:119], v18 offset:37376
    s_mov_b64 exec, -1
    v_exp_f32 v70, v70
    v_exp_f32 v71, v71
    v_cvt_pk_bf16_f32 v96, v64, v65
    v_cvt_pk_bf16_f32 v97, v66, v67
    v_cvt_pk_bf16_f32 v98, v68, v69
    v_cvt_pk_bf16_f32 v99, v70, v71
    v_exp_f32 v72, v72
    v_exp_f32 v73, v73
    v_exp_f32 v74, v74
    s_waitcnt lgkmcnt(3)
    v_mfma_f32_32x32x16_bf16 v[80:95], v[120:123], v[96:99], v[80:95]
    v_exp_f32 v75, v75
    v_exp_f32 v76, v76
    v_exp_f32 v77, v77
    v_exp_f32 v78, v78
    v_exp_f32 v79, v79
    v_cvt_pk_bf16_f32 v100, v72, v73
    v_cvt_pk_bf16_f32 v101, v74, v75
    v_cvt_pk_bf16_f32 v102, v76, v77
    v_cvt_pk_bf16_f32 v103, v78, v79
    s_setprio 0
    v_mfma_f32_32x32x16_bf16 v[64:79], v[108:111], v[4:7], v[32:47]
    ds_read_b128 v[108:111], v17 offset:39936
    v_exp_f32 v48, v48
    v_exp_f32 v49, v49
    v_exp_f32 v50, v50
    v_exp_f32 v51, v51
    v_exp_f32 v52, v52
    v_exp_f32 v53, v53
    v_mfma_f32_32x32x16_bf16 v[80:95], v[124:127], v[100:103], v[80:95]
    s_mov_b64 exec, s[92:93]
    ds_read_b128 v[120:123], v18 offset:37888
    ds_read_b128 v[124:127], v18 offset:38400
    s_mov_b64 exec, -1
    v_exp_f32 v54, v54
    v_exp_f32 v55, v55
    v_cvt_pk_bf16_f32 v96, v48, v49
    v_cvt_pk_bf16_f32 v97, v50, v51
    v_cvt_pk_bf16_f32 v98, v52, v53
    v_cvt_pk_bf16_f32 v99, v54, v55
    v_exp_f32 v56, v56
    v_exp_f32 v57, v57
    v_exp_f32 v58, v58
    s_waitcnt lgkmcnt(3)
    v_mfma_f32_32x32x16_bf16 v[80:95], v[112:115], v[96:99], v[80:95]
    v_exp_f32 v59, v59
    v_exp_f32 v60, v60
    v_exp_f32 v61, v61
    v_exp_f32 v62, v62
    v_exp_f32 v63, v63
    v_cvt_pk_bf16_f32 v100, v56, v57
    v_cvt_pk_bf16_f32 v101, v58, v59
    v_cvt_pk_bf16_f32 v102, v60, v61
    v_cvt_pk_bf16_f32 v103, v62, v63
    s_barrier
    s_setprio 2
    v_mfma_f32_32x32x16_bf16 v[48:63], v[104:107], v[4:7], v[32:47]
    ds_read_b128 v[104:107], v17 offset:0
    v_exp_f32 v64, v64
    v_exp_f32 v65, v65
    v_exp_f32 v66, v66
    v_exp_f32 v67, v67
    v_exp_f32 v68, v68
    v_exp_f32 v69, v69
    v_mfma_f32_32x32x16_bf16 v[80:95], v[116:119], v[100:103], v[80:95]
    s_mov_b64 exec, s[92:93]
    ds_read_b128 v[112:115], v18 offset:38912
    ds_read_b128 v[116:119], v18 offset:39424
    s_mov_b64 exec, -1
    v_exp_f32 v70, v70
    v_exp_f32 v71, v71
    v_cvt_pk_bf16_f32 v96, v64, v65
    v_cvt_pk_bf16_f32 v97, v66, v67
    v_cvt_pk_bf16_f32 v98, v68, v69
    v_cvt_pk_bf16_f32 v99, v70, v71
    v_exp_f32 v72, v72
    v_exp_f32 v73, v73
    v_exp_f32 v74, v74
    s_waitcnt lgkmcnt(3)
    v_mfma_f32_32x32x16_bf16 v[80:95], v[120:123], v[96:99], v[80:95]
    v_exp_f32 v75, v75
    v_exp_f32 v76, v76
    v_exp_f32 v77, v77
    v_exp_f32 v78, v78
    v_exp_f32 v79, v79
    v_cvt_pk_bf16_f32 v100, v72, v73
    v_cvt_pk_bf16_f32 v101, v74, v75
    v_cvt_pk_bf16_f32 v102, v76, v77
    v_cvt_pk_bf16_f32 v103, v78, v79
    v_mfma_f32_32x32x16_bf16 v[64:79], v[108:111], v[4:7], v[32:47]
    ds_read_b128 v[108:111], v17 offset:1024
    v_exp_f32 v48, v48
    v_exp_f32 v49, v49
    v_exp_f32 v50, v50
    v_exp_f32 v51, v51
    v_exp_f32 v52, v52
    v_exp_f32 v53, v53
    v_mfma_f32_32x32x16_bf16 v[80:95], v[124:127], v[100:103], v[80:95]
    s_mov_b64 exec, s[92:93]
    ds_read_b128 v[120:123], v18 offset:39936
    ds_read_b128 v[124:127], v18 offset:40448
    s_mov_b64 exec, -1
    v_exp_f32 v54, v54
    v_exp_f32 v55, v55
    v_cvt_pk_bf16_f32 v96, v48, v49
    v_cvt_pk_bf16_f32 v97, v50, v51
    v_cvt_pk_bf16_f32 v98, v52, v53
    v_cvt_pk_bf16_f32 v99, v54, v55
    v_exp_f32 v56, v56
    v_exp_f32 v57, v57
    v_exp_f32 v58, v58
    s_waitcnt lgkmcnt(3)
    v_mfma_f32_32x32x16_bf16 v[80:95], v[112:115], v[96:99], v[80:95]
    v_exp_f32 v59, v59
    v_exp_f32 v60, v60
    v_exp_f32 v61, v61
    v_exp_f32 v62, v62
    v_exp_f32 v63, v63
    v_cvt_pk_bf16_f32 v100, v56, v57
    v_cvt_pk_bf16_f32 v101, v58, v59
    v_cvt_pk_bf16_f32 v102, v60, v61
    v_cvt_pk_bf16_f32 v103, v62, v63
    v_mfma_f32_32x32x16_bf16 v[48:63], v[104:107], v[4:7], v[32:47]
    ds_read_b128 v[104:107], v17 offset:2048
    v_exp_f32 v64, v64
    v_exp_f32 v65, v65
    v_exp_f32 v66, v66
    v_exp_f32 v67, v67
    v_exp_f32 v68, v68
    v_exp_f32 v69, v69
    v_mfma_f32_32x32x16_bf16 v[80:95], v[116:119], v[100:103], v[80:95]
    s_mov_b64 exec, s[92:93]
    ds_read_b128 v[112:115], v18 offset:0
    ds_read_b128 v[116:119], v18 offset:512
    s_mov_b64 exec, -1
    v_exp_f32 v70, v70
    v_exp_f32 v71, v71
    v_cvt_pk_bf16_f32 v96, v64, v65
    v_cvt_pk_bf16_f32 v97, v66, v67
    v_cvt_pk_bf16_f32 v98, v68, v69
    v_cvt_pk_bf16_f32 v99, v70, v71
    v_exp_f32 v72, v72
    v_exp_f32 v73, v73
    v_exp_f32 v74, v74
    s_waitcnt lgkmcnt(3)
    v_mfma_f32_32x32x16_bf16 v[80:95], v[120:123], v[96:99], v[80:95]
    v_exp_f32 v75, v75
    v_exp_f32 v76, v76
    v_exp_f32 v77, v77
    v_exp_f32 v78, v78
    v_exp_f32 v79, v79
    v_cvt_pk_bf16_f32 v100, v72, v73
    v_cvt_pk_bf16_f32 v101, v74, v75
    v_cvt_pk_bf16_f32 v102, v76, v77
    v_cvt_pk_bf16_f32 v103, v78, v79
    v_mfma_f32_32x32x16_bf16 v[64:79], v[108:111], v[4:7], v[32:47]
    ds_read_b128 v[108:111], v17 offset:3072
    v_exp_f32 v48, v48
    v_exp_f32 v49, v49
    v_exp_f32 v50, v50
    v_exp_f32 v51, v51
    v_exp_f32 v52, v52
    v_exp_f32 v53, v53
    v_mfma_f32_32x32x16_bf16 v[80:95], v[124:127], v[100:103], v[80:95]
    s_mov_b64 exec, s[92:93]
    ds_read_b128 v[120:123], v18 offset:1024
    ds_read_b128 v[124:127], v18 offset:1536
    s_mov_b64 exec, -1
    v_exp_f32 v54, v54
    v_exp_f32 v55, v55
    v_cvt_pk_bf16_f32 v96, v48, v49
    v_cvt_pk_bf16_f32 v97, v50, v51
    v_cvt_pk_bf16_f32 v98, v52, v53
    v_cvt_pk_bf16_f32 v99, v54, v55
    v_exp_f32 v56, v56
    v_exp_f32 v57, v57
    v_exp_f32 v58, v58
    s_waitcnt lgkmcnt(3)
    v_mfma_f32_32x32x16_bf16 v[80:95], v[112:115], v[96:99], v[80:95]
    v_exp_f32 v59, v59
    v_exp_f32 v60, v60
    v_exp_f32 v61, v61
    v_exp_f32 v62, v62
    v_exp_f32 v63, v63
    v_cvt_pk_bf16_f32 v100, v56, v57
    v_cvt_pk_bf16_f32 v101, v58, v59
    v_cvt_pk_bf16_f32 v102, v60, v61
    v_cvt_pk_bf16_f32 v103, v62, v63
    s_setprio 1
    v_mfma_f32_32x32x16_bf16 v[48:63], v[104:107], v[4:7], v[32:47]
    ds_read_b128 v[104:107], v17 offset:4096
    v_exp_f32 v64, v64
    v_exp_f32 v65, v65
    v_exp_f32 v66, v66
    v_exp_f32 v67, v67
    v_exp_f32 v68, v68
    v_exp_f32 v69, v69
    v_mfma_f32_32x32x16_bf16 v[80:95], v[116:119], v[100:103], v[80:95]
    s_mov_b64 exec, s[92:93]
    ds_read_b128 v[112:115], v18 offset:2048
    ds_read_b128 v[116:119], v18 offset:2560
    s_mov_b64 exec, -1
    v_exp_f32 v70, v70
    v_exp_f32 v71, v71
    v_cvt_pk_bf16_f32 v96, v64, v65
    v_cvt_pk_bf16_f32 v97, v66, v67
    v_cvt_pk_bf16_f32 v98, v68, v69
    v_cvt_pk_bf16_f32 v99, v70, v71
    v_exp_f32 v72, v72
    v_exp_f32 v73, v73
    v_exp_f32 v74, v74
    s_waitcnt lgkmcnt(3)
    v_mfma_f32_32x32x16_bf16 v[80:95], v[120:123], v[96:99], v[80:95]
    v_exp_f32 v75, v75
    v_exp_f32 v76, v76
    v_exp_f32 v77, v77
    v_exp_f32 v78, v78
    v_exp_f32 v79, v79
    v_cvt_pk_bf16_f32 v100, v72, v73
    v_cvt_pk_bf16_f32 v101, v74, v75
    v_cvt_pk_bf16_f32 v102, v76, v77
    v_cvt_pk_bf16_f32 v103, v78, v79
    v_mfma_f32_32x32x16_bf16 v[64:79], v[108:111], v[4:7], v[32:47]
    ds_read_b128 v[108:111], v17 offset:5120
    v_exp_f32 v48, v48
    v_exp_f32 v49, v49
    v_exp_f32 v50, v50
    v_exp_f32 v51, v51
    v_exp_f32 v52, v52
    v_exp_f32 v53, v53
    v_mfma_f32_32x32x16_bf16 v[80:95], v[124:127], v[100:103], v[80:95]
    s_mov_b64 exec, s[92:93]
    ds_read_b128 v[120:123], v18 offset:3072
    ds_read_b128 v[124:127], v18 offset:3584
    s_mov_b64 exec, -1
    v_exp_f32 v54, v54
    v_exp_f32 v55, v55
    v_cvt_pk_bf16_f32 v96, v48, v49
    v_cvt_pk_bf16_f32 v97, v50, v51
    v_cvt_pk_bf16_f32 v98, v52, v53
    v_cvt_pk_bf16_f32 v99, v54, v55
    v_exp_f32 v56, v56
    v_exp_f32 v57, v57
    v_exp_f32 v58, v58
    s_waitcnt lgkmcnt(3)
    v_mfma_f32_32x32x16_bf16 v[80:95], v[112:115], v[96:99], v[80:95]
    v_exp_f32 v59, v59
    v_exp_f32 v60, v60
    v_exp_f32 v61, v61
    v_exp_f32 v62, v62
    v_exp_f32 v63, v63
    v_cvt_pk_bf16_f32 v100, v56, v57
    v_cvt_pk_bf16_f32 v101, v58, v59
    v_cvt_pk_bf16_f32 v102, v60, v61
    v_cvt_pk_bf16_f32 v103, v62, v63
    v_mfma_f32_32x32x16_bf16 v[48:63], v[104:107], v[4:7], v[32:47]
    ds_read_b128 v[104:107], v17 offset:6144
    v_exp_f32 v64, v64
    v_exp_f32 v65, v65
    v_exp_f32 v66, v66
    v_exp_f32 v67, v67
    v_exp_f32 v68, v68
    v_exp_f32 v69, v69
    v_mfma_f32_32x32x16_bf16 v[80:95], v[116:119], v[100:103], v[80:95]
    s_mov_b64 exec, s[92:93]
    ds_read_b128 v[112:115], v18 offset:4096
    ds_read_b128 v[116:119], v18 offset:4608
    s_mov_b64 exec, -1
    v_exp_f32 v70, v70
    v_exp_f32 v71, v71
    v_cvt_pk_bf16_f32 v96, v64, v65
    v_cvt_pk_bf16_f32 v97, v66, v67
    v_cvt_pk_bf16_f32 v98, v68, v69
    v_cvt_pk_bf16_f32 v99, v70, v71
    v_exp_f32 v72, v72
    v_exp_f32 v73, v73
    v_exp_f32 v74, v74
    s_waitcnt lgkmcnt(3)
    v_mfma_f32_32x32x16_bf16 v[80:95], v[120:123], v[96:99], v[80:95]
    v_exp_f32 v75, v75
    v_exp_f32 v76, v76
    v_exp_f32 v77, v77
    v_exp_f32 v78, v78
    v_exp_f32 v79, v79
    v_cvt_pk_bf16_f32 v100, v72, v73
    v_cvt_pk_bf16_f32 v101, v74, v75
    v_cvt_pk_bf16_f32 v102, v76, v77
    v_cvt_pk_bf16_f32 v103, v78, v79
    s_setprio 0
    v_mfma_f32_32x32x16_bf16 v[64:79], v[108:111], v[4:7], v[32:47]
    ds_read_b128 v[108:111], v17 offset:7168
    v_exp_f32 v48, v48
    v_exp_f32 v49, v49
    v_exp_f32 v50, v50
    v_exp_f32 v51, v51
    v_exp_f32 v52, v52
    v_exp_f32 v53, v53
    v_mfma_f32_32x32x16_bf16 v[80:95], v[124:127], v[100:103], v[80:95]
    s_mov_b64 exec, s[92:93]
    ds_read_b128 v[120:123], v18 offset:5120
    ds_read_b128 v[124:127], v18 offset:5632
    s_mov_b64 exec, -1
    v_exp_f32 v54, v54
    v_exp_f32 v55, v55
    v_cvt_pk_bf16_f32 v96, v48, v49
    v_cvt_pk_bf16_f32 v97, v50, v51
    v_cvt_pk_bf16_f32 v98, v52, v53
    v_cvt_pk_bf16_f32 v99, v54, v55
    v_exp_f32 v56, v56
    v_exp_f32 v57, v57
    v_exp_f32 v58, v58
    s_waitcnt lgkmcnt(3)
    v_mfma_f32_32x32x16_bf16 v[80:95], v[112:115], v[96:99], v[80:95]
    v_exp_f32 v59, v59
    v_exp_f32 v60, v60
    v_exp_f32 v61, v61
    v_exp_f32 v62, v62
    v_exp_f32 v63, v63
    v_cvt_pk_bf16_f32 v100, v56, v57
    v_cvt_pk_bf16_f32 v101, v58, v59
    v_cvt_pk_bf16_f32 v102, v60, v61
    v_cvt_pk_bf16_f32 v103, v62, v63
    s_barrier
    s_setprio 2
    v_mfma_f32_32x32x16_bf16 v[48:63], v[104:107], v[4:7], v[32:47]
    ds_read_b128 v[104:107], v17 offset:16384
    v_exp_f32 v64, v64
    v_exp_f32 v65, v65
    v_exp_f32 v66, v66
    v_exp_f32 v67, v67
    v_exp_f32 v68, v68
    v_exp_f32 v69, v69
    v_mfma_f32_32x32x16_bf16 v[80:95], v[116:119], v[100:103], v[80:95]
    s_mov_b64 exec, s[92:93]
    ds_read_b128 v[112:115], v18 offset:6144
    ds_read_b128 v[116:119], v18 offset:6656
    s_mov_b64 exec, -1
    v_exp_f32 v70, v70
    v_exp_f32 v71, v71
    v_cvt_pk_bf16_f32 v96, v64, v65
    v_cvt_pk_bf16_f32 v97, v66, v67
    v_cvt_pk_bf16_f32 v98, v68, v69
    v_cvt_pk_bf16_f32 v99, v70, v71
    v_exp_f32 v72, v72
    v_exp_f32 v73, v73
    v_exp_f32 v74, v74
    s_waitcnt lgkmcnt(3)
    v_mfma_f32_32x32x16_bf16 v[80:95], v[120:123], v[96:99], v[80:95]
    v_exp_f32 v75, v75
    v_exp_f32 v76, v76
    v_exp_f32 v77, v77
    v_exp_f32 v78, v78
    v_exp_f32 v79, v79
    v_cvt_pk_bf16_f32 v100, v72, v73
    v_cvt_pk_bf16_f32 v101, v74, v75
    v_cvt_pk_bf16_f32 v102, v76, v77
    v_cvt_pk_bf16_f32 v103, v78, v79
    v_mfma_f32_32x32x16_bf16 v[64:79], v[108:111], v[4:7], v[32:47]
    ds_read_b128 v[108:111], v17 offset:17408
    v_exp_f32 v48, v48
    v_exp_f32 v49, v49
    v_exp_f32 v50, v50
    v_exp_f32 v51, v51
    v_exp_f32 v52, v52
    v_exp_f32 v53, v53
    v_mfma_f32_32x32x16_bf16 v[80:95], v[124:127], v[100:103], v[80:95]
    s_mov_b64 exec, s[92:93]
    ds_read_b128 v[120:123], v18 offset:7168
    ds_read_b128 v[124:127], v18 offset:7680
    s_mov_b64 exec, -1
    v_exp_f32 v54, v54
    v_exp_f32 v55, v55
    v_cvt_pk_bf16_f32 v96, v48, v49
    v_cvt_pk_bf16_f32 v97, v50, v51
    v_cvt_pk_bf16_f32 v98, v52, v53
    v_cvt_pk_bf16_f32 v99, v54, v55
    v_exp_f32 v56, v56
    v_exp_f32 v57, v57
    v_exp_f32 v58, v58
    s_waitcnt lgkmcnt(3)
    v_mfma_f32_32x32x16_bf16 v[80:95], v[112:115], v[96:99], v[80:95]
    v_exp_f32 v59, v59
    v_exp_f32 v60, v60
    v_exp_f32 v61, v61
    v_exp_f32 v62, v62
    v_exp_f32 v63, v63
    v_cvt_pk_bf16_f32 v100, v56, v57
    v_cvt_pk_bf16_f32 v101, v58, v59
    v_cvt_pk_bf16_f32 v102, v60, v61
    v_cvt_pk_bf16_f32 v103, v62, v63
    v_mfma_f32_32x32x16_bf16 v[48:63], v[104:107], v[4:7], v[32:47]
    ds_read_b128 v[104:107], v17 offset:18432
    v_exp_f32 v64, v64
    v_exp_f32 v65, v65
    v_exp_f32 v66, v66
    v_exp_f32 v67, v67
    v_exp_f32 v68, v68
    v_exp_f32 v69, v69
    v_mfma_f32_32x32x16_bf16 v[80:95], v[116:119], v[100:103], v[80:95]
    s_mov_b64 exec, s[92:93]
    ds_read_b128 v[112:115], v18 offset:16384
    ds_read_b128 v[116:119], v18 offset:16896
    s_mov_b64 exec, -1
    v_exp_f32 v70, v70
    v_exp_f32 v71, v71
    v_cvt_pk_bf16_f32 v96, v64, v65
    v_cvt_pk_bf16_f32 v97, v66, v67
    v_cvt_pk_bf16_f32 v98, v68, v69
    v_cvt_pk_bf16_f32 v99, v70, v71
    v_exp_f32 v72, v72
    v_exp_f32 v73, v73
    v_exp_f32 v74, v74
    s_waitcnt lgkmcnt(3)
    v_mfma_f32_32x32x16_bf16 v[80:95], v[120:123], v[96:99], v[80:95]
    v_exp_f32 v75, v75
    v_exp_f32 v76, v76
    v_exp_f32 v77, v77
    v_exp_f32 v78, v78
    v_exp_f32 v79, v79
    v_cvt_pk_bf16_f32 v100, v72, v73
    v_cvt_pk_bf16_f32 v101, v74, v75
    v_cvt_pk_bf16_f32 v102, v76, v77
    v_cvt_pk_bf16_f32 v103, v78, v79
    v_mfma_f32_32x32x16_bf16 v[64:79], v[108:111], v[4:7], v[32:47]
    ds_read_b128 v[108:111], v17 offset:19456
    v_exp_f32 v48, v48
    v_exp_f32 v49, v49
    v_exp_f32 v50, v50
    v_exp_f32 v51, v51
    v_exp_f32 v52, v52
    v_exp_f32 v53, v53
    v_mfma_f32_32x32x16_bf16 v[80:95], v[124:127], v[100:103], v[80:95]
    s_mov_b64 exec, s[92:93]
    ds_read_b128 v[120:123], v18 offset:17408
    ds_read_b128 v[124:127], v18 offset:17920
    s_mov_b64 exec, -1
    v_exp_f32 v54, v54
    v_exp_f32 v55, v55
    v_cvt_pk_bf16_f32 v96, v48, v49
    v_cvt_pk_bf16_f32 v97, v50, v51
    v_cvt_pk_bf16_f32 v98, v52, v53
    v_cvt_pk_bf16_f32 v99, v54, v55
    v_exp_f32 v56, v56
    v_exp_f32 v57, v57
    v_exp_f32 v58, v58
    s_waitcnt lgkmcnt(3)
    v_mfma_f32_32x32x16_bf16 v[80:95], v[112:115], v[96:99], v[80:95]
    v_exp_f32 v59, v59
    v_exp_f32 v60, v60
    v_exp_f32 v61, v61
    v_exp_f32 v62, v62
    v_exp_f32 v63, v63
    v_cvt_pk_bf16_f32 v100, v56, v57
    v_cvt_pk_bf16_f32 v101, v58, v59
    v_cvt_pk_bf16_f32 v102, v60, v61
    v_cvt_pk_bf16_f32 v103, v62, v63
    s_setprio 1
    v_mfma_f32_32x32x16_bf16 v[48:63], v[104:107], v[4:7], v[32:47]
    ds_read_b128 v[104:107], v17 offset:20480
    v_exp_f32 v64, v64
    v_exp_f32 v65, v65
    v_exp_f32 v66, v66
    v_exp_f32 v67, v67
    v_exp_f32 v68, v68
    v_exp_f32 v69, v69
    v_mfma_f32_32x32x16_bf16 v[80:95], v[116:119], v[100:103], v[80:95]
    s_mov_b64 exec, s[92:93]
    ds_read_b128 v[112:115], v18 offset:18432
    ds_read_b128 v[116:119], v18 offset:18944
    s_mov_b64 exec, -1
    v_exp_f32 v70, v70
    v_exp_f32 v71, v71
    v_cvt_pk_bf16_f32 v96, v64, v65
    v_cvt_pk_bf16_f32 v97, v66, v67
    v_cvt_pk_bf16_f32 v98, v68, v69
    v_cvt_pk_bf16_f32 v99, v70, v71
    v_exp_f32 v72, v72
    v_exp_f32 v73, v73
    v_exp_f32 v74, v74
    s_waitcnt lgkmcnt(3)
    v_mfma_f32_32x32x16_bf16 v[80:95], v[120:123], v[96:99], v[80:95]
    v_exp_f32 v75, v75
    v_exp_f32 v76, v76
    v_exp_f32 v77, v77
    v_exp_f32 v78, v78
    v_exp_f32 v79, v79
    v_cvt_pk_bf16_f32 v100, v72, v73
    v_cvt_pk_bf16_f32 v101, v74, v75
    v_cvt_pk_bf16_f32 v102, v76, v77
    v_cvt_pk_bf16_f32 v103, v78, v79
    v_mfma_f32_32x32x16_bf16 v[64:79], v[108:111], v[4:7], v[32:47]
    ds_read_b128 v[108:111], v17 offset:21504
    v_exp_f32 v48, v48
    v_exp_f32 v49, v49
    v_exp_f32 v50, v50
    v_exp_f32 v51, v51
    v_exp_f32 v52, v52
    v_exp_f32 v53, v53
    v_mfma_f32_32x32x16_bf16 v[80:95], v[124:127], v[100:103], v[80:95]
    s_mov_b64 exec, s[92:93]
    ds_read_b128 v[120:123], v18 offset:19456
    ds_read_b128 v[124:127], v18 offset:19968
    s_mov_b64 exec, -1
    v_exp_f32 v54, v54
    v_exp_f32 v55, v55
    v_cvt_pk_bf16_f32 v96, v48, v49
    v_cvt_pk_bf16_f32 v97, v50, v51
    v_cvt_pk_bf16_f32 v98, v52, v53
    v_cvt_pk_bf16_f32 v99, v54, v55
    v_exp_f32 v56, v56
    v_exp_f32 v57, v57
    v_exp_f32 v58, v58
    s_waitcnt lgkmcnt(3)
    v_mfma_f32_32x32x16_bf16 v[80:95], v[112:115], v[96:99], v[80:95]
    v_exp_f32 v59, v59
    v_exp_f32 v60, v60
    v_exp_f32 v61, v61
    v_exp_f32 v62, v62
    v_exp_f32 v63, v63
    v_cvt_pk_bf16_f32 v100, v56, v57
    v_cvt_pk_bf16_f32 v101, v58, v59
    v_cvt_pk_bf16_f32 v102, v60, v61
    v_cvt_pk_bf16_f32 v103, v62, v63
    v_mfma_f32_32x32x16_bf16 v[48:63], v[104:107], v[4:7], v[32:47]
    ds_read_b128 v[104:107], v17 offset:22528
    v_exp_f32 v64, v64
    v_exp_f32 v65, v65
    v_exp_f32 v66, v66
    v_exp_f32 v67, v67
    v_exp_f32 v68, v68
    v_exp_f32 v69, v69
    v_mfma_f32_32x32x16_bf16 v[80:95], v[116:119], v[100:103], v[80:95]
    s_mov_b64 exec, s[92:93]
    ds_read_b128 v[112:115], v18 offset:20480
    ds_read_b128 v[116:119], v18 offset:20992
    s_mov_b64 exec, -1
    v_exp_f32 v70, v70
    v_exp_f32 v71, v71
    v_cvt_pk_bf16_f32 v96, v64, v65
    v_cvt_pk_bf16_f32 v97, v66, v67
    v_cvt_pk_bf16_f32 v98, v68, v69
    v_cvt_pk_bf16_f32 v99, v70, v71
    v_exp_f32 v72, v72
    v_exp_f32 v73, v73
    v_exp_f32 v74, v74
    s_waitcnt lgkmcnt(3)
    v_mfma_f32_32x32x16_bf16 v[80:95], v[120:123], v[96:99], v[80:95]
    v_exp_f32 v75, v75
    v_exp_f32 v76, v76
    v_exp_f32 v77, v77
    v_exp_f32 v78, v78
    v_exp_f32 v79, v79
    v_cvt_pk_bf16_f32 v100, v72, v73
    v_cvt_pk_bf16_f32 v101, v74, v75
    v_cvt_pk_bf16_f32 v102, v76, v77
    v_cvt_pk_bf16_f32 v103, v78, v79
    s_setprio 0
    v_mfma_f32_32x32x16_bf16 v[64:79], v[108:111], v[4:7], v[32:47]
    ds_read_b128 v[108:111], v17 offset:23552
    v_exp_f32 v48, v48
    v_exp_f32 v49, v49
    v_exp_f32 v50, v50
    v_exp_f32 v51, v51
    v_exp_f32 v52, v52
    v_exp_f32 v53, v53
    v_mfma_f32_32x32x16_bf16 v[80:95], v[124:127], v[100:103], v[80:95]
    s_mov_b64 exec, s[92:93]
    ds_read_b128 v[120:123], v18 offset:21504
    ds_read_b128 v[124:127], v18 offset:22016
    s_mov_b64 exec, -1
    v_exp_f32 v54, v54
    v_exp_f32 v55, v55
    v_cvt_pk_bf16_f32 v96, v48, v49
    v_cvt_pk_bf16_f32 v97, v50, v51
    v_cvt_pk_bf16_f32 v98, v52, v53
    v_cvt_pk_bf16_f32 v99, v54, v55
    v_exp_f32 v56, v56
    v_exp_f32 v57, v57
    v_exp_f32 v58, v58
    s_waitcnt lgkmcnt(3)
    v_mfma_f32_32x32x16_bf16 v[80:95], v[112:115], v[96:99], v[80:95]
    v_exp_f32 v59, v59
    v_exp_f32 v60, v60
    v_exp_f32 v61, v61
    v_exp_f32 v62, v62
    v_exp_f32 v63, v63
    v_cvt_pk_bf16_f32 v100, v56, v57
    v_cvt_pk_bf16_f32 v101, v58, v59
    v_cvt_pk_bf16_f32 v102, v60, v61
    v_cvt_pk_bf16_f32 v103, v62, v63
    s_setprio 2
    v_mfma_f32_32x32x16_bf16 v[48:63], v[104:107], v[4:7], v[32:47]
    v_exp_f32 v64, v64
    v_exp_f32 v65, v65
    v_exp_f32 v66, v66
    v_exp_f32 v67, v67
    v_exp_f32 v68, v68
    v_exp_f32 v69, v69
    v_mfma_f32_32x32x16_bf16 v[80:95], v[116:119], v[100:103], v[80:95]
    s_mov_b64 exec, s[92:93]
    ds_read_b128 v[112:115], v18 offset:22528
    ds_read_b128 v[116:119], v18 offset:23040
    s_mov_b64 exec, -1
    v_exp_f32 v70, v70
    v_exp_f32 v71, v71
    v_cvt_pk_bf16_f32 v96, v64, v65
    v_cvt_pk_bf16_f32 v97, v66, v67
    v_cvt_pk_bf16_f32 v98, v68, v69
    v_cvt_pk_bf16_f32 v99, v70, v71
    v_exp_f32 v72, v72
    v_exp_f32 v73, v73
    v_exp_f32 v74, v74
    s_waitcnt lgkmcnt(2)
    v_mfma_f32_32x32x16_bf16 v[80:95], v[120:123], v[96:99], v[80:95]
    v_exp_f32 v75, v75
    v_exp_f32 v76, v76
    v_exp_f32 v77, v77
    v_exp_f32 v78, v78
    v_exp_f32 v79, v79
    v_cvt_pk_bf16_f32 v100, v72, v73
    v_cvt_pk_bf16_f32 v101, v74, v75
    v_cvt_pk_bf16_f32 v102, v76, v77
    v_cvt_pk_bf16_f32 v103, v78, v79
    v_mfma_f32_32x32x16_bf16 v[64:79], v[108:111], v[4:7], v[32:47]
    v_exp_f32 v48, v48
    v_exp_f32 v49, v49
    v_exp_f32 v50, v50
    v_exp_f32 v51, v51
    v_exp_f32 v52, v52
    v_exp_f32 v53, v53
    v_mfma_f32_32x32x16_bf16 v[80:95], v[124:127], v[100:103], v[80:95]
    s_mov_b64 exec, s[92:93]
    ds_read_b128 v[120:123], v18 offset:23552
    ds_read_b128 v[124:127], v18 offset:24064
    s_mov_b64 exec, -1
    v_exp_f32 v54, v54
    v_exp_f32 v55, v55
    v_cvt_pk_bf16_f32 v96, v48, v49
    v_cvt_pk_bf16_f32 v97, v50, v51
    v_cvt_pk_bf16_f32 v98, v52, v53
    v_cvt_pk_bf16_f32 v99, v54, v55
    v_exp_f32 v56, v56
    v_exp_f32 v57, v57
    v_exp_f32 v58, v58
    s_waitcnt lgkmcnt(2)
    v_mfma_f32_32x32x16_bf16 v[80:95], v[112:115], v[96:99], v[80:95]
    v_exp_f32 v59, v59
    v_exp_f32 v60, v60
    v_exp_f32 v61, v61
    v_exp_f32 v62, v62
    v_exp_f32 v63, v63
    v_cvt_pk_bf16_f32 v100, v56, v57
    v_cvt_pk_bf16_f32 v101, v58, v59
    v_cvt_pk_bf16_f32 v102, v60, v61
    v_cvt_pk_bf16_f32 v103, v62, v63
    v_exp_f32 v64, v64
    v_exp_f32 v65, v65
    v_exp_f32 v66, v66
    v_exp_f32 v67, v67
    v_exp_f32 v68, v68
    v_exp_f32 v69, v69
    v_mfma_f32_32x32x16_bf16 v[80:95], v[116:119], v[100:103], v[80:95]
    v_exp_f32 v70, v70
    v_exp_f32 v71, v71
    v_cvt_pk_bf16_f32 v96, v64, v65
    v_cvt_pk_bf16_f32 v97, v66, v67
    v_cvt_pk_bf16_f32 v98, v68, v69
    v_cvt_pk_bf16_f32 v99, v70, v71
    v_exp_f32 v72, v72
    v_exp_f32 v73, v73
    v_exp_f32 v74, v74
    s_waitcnt lgkmcnt(0)
    v_mfma_f32_32x32x16_bf16 v[80:95], v[120:123], v[96:99], v[80:95]
    v_exp_f32 v75, v75
    v_exp_f32 v76, v76
    v_exp_f32 v77, v77
    v_exp_f32 v78, v78
    v_exp_f32 v79, v79
    v_cvt_pk_bf16_f32 v100, v72, v73
    v_cvt_pk_bf16_f32 v101, v74, v75
    v_cvt_pk_bf16_f32 v102, v76, v77
    v_cvt_pk_bf16_f32 v103, v78, v79
    s_nop 1
    v_mfma_f32_32x32x16_bf16 v[80:95], v[124:127], v[100:103], v[80:95]
    v_bfe_u32 v14, v1, 2, 3
    v_lshlrev_b32 v14, 10, v14
    v_and_b32 v11, 3, v1
    v_lshlrev_b32 v11, 5, v11
    v_lshrrev_b32 v15, 5, v1
    v_lshlrev_b32 v15, 4, v15
    v_add3_u32 v11, v11, v14, v15
    s_lshl_b32 s51, s3, 3
    s_add_u32 s51, s51, s6
    s_lshl_b32 s51, s51, 10
    s_lshl_b32 s49, s5, 7
    s_add_u32 s51, s51, s49
    s_add_u32 s51, s51, 3145728
    s_waitcnt vmcnt(0)
    v_sub_f32 v13, 1.0, v10
    s_mov_b32 s48, 0x17800000
    v_cmp_nle_f32 vcc, s48, v88
    s_cbranch_vccz L_fb_done
    v_and_b32 v3, 0x1fff, v18
    v_mov_b32 v12, 0xff61b1e6
    s_mov_b32 s48, 0
L_fb1:
    s_lshr_b32 s49, s48, 3
    s_lshl_b32 s49, s49, 14
    s_and_b32 s50, s48, 7
    s_lshl_b32 s50, s50, 10
    s_add_u32 s49, s49, s50
    buffer_load_dwordx4 v[104:107], v16, s[16:19], s49 offen sc1
    s_waitcnt vmcnt(0)
    v_mfma_f32_32x32x16_bf16 v[48:63], v[104:107], v[4:7], 0
    s_nop 11
    v_max3_f32 v12, v12, v48, v49
    v_max3_f32 v12, v12, v50, v51
    v_max3_f32 v12, v12, v52, v53
    v_max3_f32 v12, v12, v54, v55
    v_max3_f32 v12, v12, v56, v57
    v_max3_f32 v12, v12, v58, v59
    v_max3_f32 v12, v12, v60, v61
    v_max3_f32 v12, v12, v62, v63
    s_add_u32 s48, s48, 1
    s_cmp_lt_u32 s48, 64
    s_cbranch_scc1 L_fb1
    v_mov_b32 v2, v12
    s_nop 1
    v_permlane32_swap_b32 v12, v2
    v_max_f32 v12, v12, v2
    v_sub_f32 v32, 0, v12
    v_mov_b32 v33, v32
    v_mov_b32 v34, v32
    v_mov_b32 v35, v32
    v_mov_b32 v36, v32
    v_mov_b32 v37, v32
    v_mov_b32 v38, v32
    v_mov_b32 v39, v32
    v_mov_b32 v40, v32
    v_mov_b32 v41, v32
    v_mov_b32 v42, v32
    v_mov_b32 v43, v32
    v_mov_b32 v44, v32
    v_mov_b32 v45, v32
    v_mov_b32 v46, v32
    v_mov_b32 v47, v32
    v_mov_b32 v80, 0
    v_mov_b32 v81, 0
    v_mov_b32 v82, 0
    v_mov_b32 v83, 0
    v_mov_b32 v84, 0
    v_mov_b32 v85, 0
    v_mov_b32 v86, 0
    v_mov_b32 v87, 0
    v_mov_b32 v88, 0
    v_mov_b32 v89, 0
    v_mov_b32 v90, 0
    v_mov_b32 v91, 0
    v_mov_b32 v92, 0
    v_mov_b32 v93, 0
    v_mov_b32 v94, 0
    v_mov_b32 v95, 0
    s_mov_b32 s48, 0
L_fb2:
    s_lshr_b32 s49, s48, 3
    s_lshl_b32 s49, s49, 14
    s_and_b32 s50, s48, 7
    s_lshl_b32 s50, s50, 10
    s_add_u32 s49, s49, s50
    s_add_u32 s50, s49, 8192
    buffer_load_dwordx4 v[104:107], v16, s[16:19], s49 offen sc1
    s_mov_b64 exec, s[92:93]
    buffer_load_dwordx4 v[112:115], v3, s[16:19], s50 offen sc1
    buffer_load_dwordx4 v[116:119], v3, s[16:19], s50 offen offset:512 sc1
    s_mov_b64 exec, -1
    s_waitcnt vmcnt(0)
    v_mfma_f32_32x32x16_bf16 v[48:63], v[104:107], v[4:7], v[32:47]
    s_nop 11
    v_exp_f32 v48, v48
    v_exp_f32 v49, v49
    v_exp_f32 v50, v50
    v_exp_f32 v51, v51
    v_exp_f32 v52, v52
    v_exp_f32 v53, v53
    v_exp_f32 v54, v54
    v_exp_f32 v55, v55
    v_exp_f32 v56, v56
    v_exp_f32 v57, v57
    v_exp_f32 v58, v58
    v_exp_f32 v59, v59
    v_exp_f32 v60, v60
    v_exp_f32 v61, v61
    v_exp_f32 v62, v62
    v_exp_f32 v63, v63
    v_cvt_pk_bf16_f32 v96, v48, v49
    v_cvt_pk_bf16_f32 v97, v50, v51
    v_cvt_pk_bf16_f32 v98, v52, v53
    v_cvt_pk_bf16_f32 v99, v54, v55
    v_cvt_pk_bf16_f32 v100, v56, v57
    v_cvt_pk_bf16_f32 v101, v58, v59
    v_cvt_pk_bf16_f32 v102, v60, v61
    v_cvt_pk_bf16_f32 v103, v62, v63
    v_mfma_f32_32x32x16_bf16 v[80:95], v[112:115], v[96:99], v[80:95]
    s_nop 0
    v_mfma_f32_32x32x16_bf16 v[80:95], v[116:119], v[100:103], v[80:95]
    s_add_u32 s48, s48, 1
    s_cmp_lt_u32 s48, 64
    s_cbranch_scc1 L_fb2
    s_nop 11
L_fb_done:
    v_rcp_f32 v12, v88
    s_nop 0
    v_mul_f32 v12, v12, v13
    v_mul_f32 v80, v80, v12
    v_mul_f32 v81, v81, v12
    v_mul_f32 v82, v82, v12
    v_mul_f32 v83, v83, v12
    v_mul_f32 v84, v84, v12
    v_mul_f32 v85, v85, v12
    v_mul_f32 v86, v86, v12
    v_mul_f32 v87, v87, v12
    v_cvt_pk_bf16_f32 v96, v80, v81
    v_cvt_pk_bf16_f32 v97, v82, v83
    v_cvt_pk_bf16_f32 v98, v84, v85
    v_cvt_pk_bf16_f32 v99, v86, v87
    buffer_store_dwordx4 v[96:99], v11, s[16:19], s51 offen sc1
    s_barrier
    s_endpgm
L_sw:
    s_nop 1
    s_add_u32 m0, s56, 0
    s_add_u32 s95, s60, s52
    buffer_load_dwordx4 v29, s[8:11], s95 offen lds
    s_add_u32 m0, s96, 147456
    s_nop 0
    buffer_load_dwordx4 v16, s[24:27], s96 offen offset:0 lds
    s_add_u32 m0, s56, 20480
    s_add_u32 s95, s60, s53
    buffer_load_dwordx4 v29, s[8:11], s95 offen lds
    s_add_u32 m0, s96, 147456
    s_nop 0
    buffer_load_dwordx4 v16, s[24:27], s96 offen offset:1024 lds
    s_add_u32 m0, s56, 40960
    s_add_u32 s95, s60, s54
    buffer_load_dwordx4 v29, s[8:11], s95 offen lds
    s_add_u32 m0, s96, 147456
    s_nop 0
    buffer_load_dwordx4 v16, s[24:27], s96 offen offset:2048 lds
    s_add_u32 m0, s56, 61440
    s_add_u32 s95, s60, s55
    buffer_load_dwordx4 v29, s[8:11], s95 offen lds
    s_add_u32 m0, s96, 147456
    s_nop 0
    buffer_load_dwordx4 v16, s[24:27], s96 offen offset:3072 lds
    s_mov_b32 s72, 3072
    s_lshl_b32 s48, s90, 10
    s_cmp_eq_u32 s90, 3
    s_cselect_b32 s12, s44, s12
    s_cselect_b32 s13, s45, s13
    s_cselect_b32 s14, s46, s14
    s_cselect_b32 s72, 1024, s72
    s_cselect_b32 s48, 0, s48
    v_lshrrev_b32 v10, 3, v1
    v_and_b32 v11, 7, v1
    v_bfe_u32 v12, v1, 4, 1
    v_lshlrev_b32 v12, 2, v12
    v_xor_b32 v11, v11, v12
    v_lshlrev_b32 v11, 4, v11
    s_lshl_b32 s51, s5, 7
    v_lshlrev_b32 v12, 10, v10
    v_add3_u32 v30, v12, v11, s51
    v_mul_lo_u32 v12, v10, s72
    s_add_u32 s48, s48, s51
    v_add3_u32 v31, v12, v11, s48
    s_lshl_b32 s71, s72, 3
    s_add_u32 s89, s96, 81920
    s_add_u32 m0, s57, 0
    s_add_u32 s95, s61, s52
    buffer_load_dwordx4 v29, s[8:11], s95 offen lds
    s_add_u32 m0, s58, 0
    s_add_u32 s95, s62, s52
    buffer_load_dwordx4 v29, s[8:11], s95 offen lds
    s_add_u32 m0, s59, 0
    s_add_u32 s95, s63, s52
    buffer_load_dwordx4 v29, s[8:11], s95 offen lds
    s_add_u32 m0, s91, 0
    s_add_u32 s95, s99, s52
    buffer_load_dwordx4 v29, s[8:11], s95 offen lds
    s_lshr_b32 s70, s72, 1
    s_mul_i32 s70, s70, s52
    s_sub_u32 s70, s70, s71
    s_add_u32 m0, s89, 0
    s_add_u32 s70, s70, s71
    buffer_load_dwordx4 v31, s[12:15], s70 offen lds
    s_add_u32 m0, s89, 1024
    s_add_u32 s70, s70, s71
    buffer_load_dwordx4 v31, s[12:15], s70 offen lds
    s_add_u32 m0, s89, 2048
    s_add_u32 s70, s70, s71
    buffer_load_dwordx4 v31, s[12:15], s70 offen lds
    s_add_u32 m0, s89, 3072
    s_add_u32 s70, s70, s71
    buffer_load_dwordx4 v31, s[12:15], s70 offen lds
    s_cmp_lg_u32 s90, 3
    s_cbranch_scc1 L_sw_norst
    s_lshl_b32 s48, s88, 7
    s_add_u32 s48, s48, 147456
    v_mov_b32 v8, s48
    v_mov_b32 v10, 0
    v_mov_b32 v11, 0
    s_mov_b64 exec, 1
    buffer_store_dwordx2 v[10:11], v8, s[16:19], 0 offen offset:4 sc1
    s_mov_b64 exec, -1
L_sw_norst:
    s_lshl_b32 s78, s90, 14
    s_add_u32 s78, s78, 49152
    s_cmp_eq_u32 s90, 3
    s_cselect_b32 s78, 131072, s78
    v_and_b32 v10, 15, v1
    v_lshrrev_b32 v11, 4, v1
    s_lshl_b32 s49, s90, 9
    s_add_u32 s50, s49, 108544
    v_lshlrev_b32 v12, 6, v10
    v_lshlrev_b32 v13, 4, v11
    v_add3_u32 v152, v12, v13, s50
    s_add_u32 s50, s49, 98816
    v_lshlrev_b32 v12, 5, v10
    v_and_b32 v13, 1, v11
    v_lshlrev_b32 v13, 4, v13
    v_add3_u32 v153, v12, v13, s50
    s_add_u32 s50, s49, 118784
    v_bfe_u32 v12, v1, 2, 2
    v_lshlrev_b32 v12, 6, v12
    v_lshlrev_b32 v13, 8, v11
    v_and_b32 v14, 3, v1
    v_lshlrev_b32 v14, 3, v14
    v_add3_u32 v154, v12, v13, v14
    v_add_u32 v154, s50, v154
    v_lshlrev_b32 v12, 7, v10
    v_lshlrev_b32 v13, 3, v11
    v_add3_u32 v155, v12, v13, s78
    s_mov_b32 s80, 0x55555555
    s_mov_b32 s81, 0xaaaaaaaa
    s_mov_b32 s82, 0x55555555
    s_mov_b32 s83, 0x55555555
    s_mov_b32 s84, 0xaaaaaaaa
    s_mov_b32 s85, 0xaaaaaaaa
    v_lshrrev_b32 v12, 1, v10
    v_lshlrev_b32 v13, 2, v11
    v_sub_u32 v14, v13, v12
    v_mov_b32 v15, 0xf149f2ca
    s_add_u32 s50, s4, s90
    s_cmp_eq_u32 s50, 0
    s_cselect_b32 s50, 8, 0
    v_add_u32 v12, -1, v14
    v_add_u32 v6, 0, v13
    v_cmp_gt_u32 vcc, 8, v12
    v_cmp_le_u32 s[48:49], s50, v6
    s_nop 0
    v_cndmask_b32 v156, v15, 0, vcc
    v_cndmask_b32 v156, v15, v156, s[48:49]
    v_add_u32 v12, 0, v14
    v_add_u32 v6, 1, v13
    v_cmp_gt_u32 vcc, 8, v12
    v_cmp_le_u32 s[48:49], s50, v6
    s_nop 0
    v_cndmask_b32 v157, v15, 0, vcc
    v_cndmask_b32 v157, v15, v157, s[48:49]
    v_add_u32 v12, 1, v14
    v_add_u32 v6, 2, v13
    v_cmp_gt_u32 vcc, 8, v12
    v_cmp_le_u32 s[48:49], s50, v6
    s_nop 0
    v_cndmask_b32 v158, v15, 0, vcc
    v_cndmask_b32 v158, v15, v158, s[48:49]
    v_add_u32 v12, 2, v14
    v_add_u32 v6, 3, v13
    v_cmp_gt_u32 vcc, 8, v12
    v_cmp_le_u32 s[48:49], s50, v6
    s_nop 0
    v_cndmask_b32 v159, v15, 0, vcc
    v_cndmask_b32 v159, v15, v159, s[48:49]
    v_mov_b32 v160, 0x3f803f80
    v_mov_b32 v161, 0x3f803f80
    v_mov_b32 v162, 0x3f803f80
    v_mov_b32 v163, 0x3f803f80
    v_mov_b32 v48, 0
    v_mov_b32 v49, 0
    v_mov_b32 v50, 0
    v_mov_b32 v51, 0
    v_mov_b32 v52, 0
    v_mov_b32 v53, 0
    v_mov_b32 v54, 0
    v_mov_b32 v55, 0
    v_mov_b32 v56, 0
    v_mov_b32 v57, 0
    v_mov_b32 v58, 0
    v_mov_b32 v59, 0
    v_mov_b32 v60, 0
    v_mov_b32 v61, 0
    v_mov_b32 v62, 0
    v_mov_b32 v63, 0
    v_lshrrev_b32 v8, 3, v1
    v_and_b32 v9, 7, v1
    v_lshlrev_b32 v9, 4, v9
    v_lshlrev_b32 v8, 10, v8
    v_add_u32 v164, v8, v9
    v_lshrrev_b32 v8, 4, v19
    v_lshlrev_b32 v8, 7, v8
    v_and_b32 v9, 15, v1
    v_lshlrev_b32 v9, 2, v9
    v_add_u32 v165, v8, v9
    v_add_u32 v166, s78, v16
    s_lshl_b32 s48, s90, 4
    s_add_u32 s48, s48, s6
    s_lshl_b32 s48, s48, 10
    s_lshl_b32 s49, s5, 7
    s_add_u32 s74, s48, s49
    s_lshl_b32 s75, s4, 9
    s_add_u32 s75, s75, 180224
    s_lshl_b32 s79, s90, 17
    v_and_b32 v12, 1, v11
    v_lshrrev_b32 v13, 1, v11
    v_bfe_u32 v14, v1, 2, 2
    v_lshlrev_b32 v13, 2, v13
    v_add_u32 v13, v13, v14
    v_lshlrev_b32 v13, 7, v13
    v_lshrrev_b32 v14, 1, v14
    v_lshlrev_b32 v14, 6, v14
    v_lshlrev_b32 v12, 5, v12
    v_add3_u32 v14, v14, v13, v12
    v_and_b32 v12, 3, v1
    v_lshlrev_b32 v12, 3, v12
    v_add3_u32 v2, v14, v12, s78
    v_xor_b32 v3, 64, v2
    v_lshrrev_b32 v12, 1, v19
    v_and_b32 v13, 1, v19
    v_lshlrev_b32 v13, 3, v13
    v_lshrrev_b32 v14, 5, v1
    v_or_b32 v13, v13, v14
    v_xor_b32 v13, v13, v12
    v_lshlrev_b32 v13, 4, v13
    v_lshlrev_b32 v12, 8, v12
    v_add3_u32 v4, v12, v13, s78
    v_xor_b32 v5, 32, v4
    v_xor_b32 v6, 64, v4
    v_xor_b32 v7, 96, v4
    v_add_u32 v12, 0, v11
    v_xor_b32 v13, v10, v12
    v_lshlrev_b32 v12, 1, v12
    v_lshrrev_b32 v14, 3, v13
    v_add_u32 v12, v12, v14
    v_lshlrev_b32 v12, 10, v12
    v_and_b32 v13, 7, v13
    v_lshlrev_b32 v13, 4, v13
    v_add_u32 v20, v12, v13
    v_add_u32 v12, 4, v11
    v_xor_b32 v13, v10, v12
    v_lshlrev_b32 v12, 1, v12
    v_lshrrev_b32 v14, 3, v13
    v_add_u32 v12, v12, v14
    v_lshlrev_b32 v12, 10, v12
    v_and_b32 v13, 7, v13
    v_lshlrev_b32 v13, 4, v13
    v_add_u32 v21, v12, v13
    v_add_u32 v12, 8, v11
    v_xor_b32 v13, v10, v12
    v_lshlrev_b32 v12, 1, v12
    v_lshrrev_b32 v14, 3, v13
    v_add_u32 v12, v12, v14
    v_lshlrev_b32 v12, 10, v12
    v_and_b32 v13, 7, v13
    v_lshlrev_b32 v13, 4, v13
    v_add_u32 v22, v12, v13
    v_add_u32 v12, 12, v11
    v_xor_b32 v13, v10, v12
    v_lshlrev_b32 v12, 1, v12
    v_lshrrev_b32 v14, 3, v13
    v_add_u32 v12, v12, v14
    v_lshlrev_b32 v12, 10, v12
    v_and_b32 v13, 7, v13
    v_lshlrev_b32 v13, 4, v13
    v_add_u32 v23, v12, v13
    v_and_b32 v12, 1, v1
    s_lshl_b32 s48, s4, 3
    s_lshl_b32 s49, s90, 1
    s_add_u32 s48, s48, s49
    v_add_u32 v28, s48, v12
    v_lshlrev_b32 v28, 7, v28
    s_lshl_b32 s86, s6, 10
    s_lshl_b32 s48, s90, 8
    s_add_u32 s86, s86, s48
    v_lshrrev_b32 v9, 5, v1
    v_lshlrev_b32 v8, 5, v19
    v_lshlrev_b32 v9, 4, v9
    s_mul_i32 s49, s90, 10240
    s_add_u32 s49, s49, 98816
    s_cmp_eq_u32 s90, 3
    s_cselect_b32 s49, 108544, s49
    v_add3_u32 v167, v8, v9, s49
    s_waitcnt vmcnt(8)
    s_barrier
    s_add_u32 m0, s89, 16384
    s_add_u32 s70, s70, s71
    buffer_load_dwordx4 v31, s[12:15], s70 offen lds
    s_add_u32 m0, s89, 17408
    s_add_u32 s70, s70, s71
    buffer_load_dwordx4 v31, s[12:15], s70 offen lds
    s_add_u32 m0, s89, 18432
    s_add_u32 s70, s70, s71
    buffer_load_dwordx4 v31, s[12:15], s70 offen lds
    s_add_u32 m0, s89, 19456
    s_add_u32 s70, s70, s71
    buffer_load_dwordx4 v31, s[12:15], s70 offen lds
    s_add_u32 m0, s89, 32768
    s_add_u32 s70, s70, s71
    buffer_load_dwordx4 v31, s[12:15], s70 offen lds
    s_add_u32 m0, s89, 33792
    s_add_u32 s70, s70, s71
    buffer_load_dwordx4 v31, s[12:15], s70 offen lds
    s_add_u32 m0, s89, 34816
    s_add_u32 s70, s70, s71
    buffer_load_dwordx4 v31, s[12:15], s70 offen lds
    s_add_u32 m0, s89, 35840
    s_add_u32 s70, s70, s71
    buffer_load_dwordx4 v31, s[12:15], s70 offen lds
    v_and_b32 v24, 3, v1
    v_lshlrev_b32 v24, 6, v24
    v_mov_b32 v25, 45056
    s_waitcnt vmcnt(8)
    s_barrier
    s_cmp_lg_u32 s90, 3
    s_cbranch_scc1 L_kvf_done
    v_lshlrev_b32 v65, 2, v1
    ds_read_b128 v[68:71], v16 offset:61440
    ds_read_b128 v[72:75], v16 offset:62464
    ds_read_b128 v[76:79], v16 offset:63488
    ds_read_b128 v[80:83], v16 offset:64512
    ds_read_b32 v84, v65 offset:40960
    ds_read_b32 v85, v65 offset:41216
    ds_read_b32 v86, v65 offset:41472
    ds_read_b32 v87, v65 offset:41728
    s_lshl_b32 s48, s4, 1
    s_lshr_b32 s49, s7, 1
    s_add_u32 s48, s48, s49
    s_lshr_b32 s49, s48, 3
    s_lshl_b32 s49, s49, 14
    s_and_b32 s51, s48, 7
    s_lshl_b32 s51, s51, 10
    s_add_u32 s49, s49, s51
    s_and_b32 s50, s7, 1
    v_and_b32 v66, 15, v1
    v_bfe_u32 v67, v1, 4, 1
    v_lshlrev_b32 v64, 4, v66
    v_lshrrev_b32 v65, 5, v1
    v_lshlrev_b32 v65, 3, v65
    v_add_u32 v65, v65, v64
    s_waitcnt lgkmcnt(4)
    v_add_f32 v68, v68, v72
    v_add_f32 v76, v76, v80
    v_add_f32 v69, v69, v73
    v_add_f32 v77, v77, v81
    v_add_f32 v70, v70, v74
    v_add_f32 v78, v78, v82
    v_add_f32 v71, v71, v75
    v_add_f32 v79, v79, v83
    v_add_f32 v68, v68, v76
    v_add_f32 v69, v69, v77
    v_add_f32 v70, v70, v78
    v_add_f32 v71, v71, v79
    s_cmp_ge_u32 s5, 4
    s_cbranch_scc1 L_kvf_V
    s_lshl_b32 s51, s50, 8
    s_add_u32 s49, s49, s51
    v_lshlrev_b32 v67, 9, v67
    v_add_u32 v67, v67, v65
    s_mov_b32 s51, 0x3eb8aa3b
    v_mul_f32 v68, s51, v68
    v_mul_f32 v69, s51, v69
    v_mul_f32 v70, s51, v70
    v_mul_f32 v71, s51, v71
    v_cvt_pk_bf16_f32 v72, v68, v69
    v_cvt_pk_bf16_f32 v73, v70, v71
    buffer_store_dwordx2 v[72:73], v67, s[16:19], s49 offen sc1
    v_mul_f32 v76, v68, v68
    v_fmac_f32 v76, v69, v69
    v_fmac_f32 v76, v70, v70
    v_fmac_f32 v76, v71, v71
    v_mov_b32 v77, v76
    s_nop 1
    v_permlane32_swap_b32 v76, v77
    v_add_f32 v76, v76, v77
    v_mov_b32 v77, v76
    s_nop 1
    v_permlane16_swap_b32 v76, v77
    v_add_f32 v76, v76, v77
    s_nop 1
    v_max_f32_dpp v76, v76, v76 row_ror:8 row_mask:0xf bank_mask:0xf
    s_nop 1
    v_max_f32_dpp v76, v76, v76 row_ror:4 row_mask:0xf bank_mask:0xf
    s_nop 1
    v_max_f32_dpp v76, v76, v76 row_ror:2 row_mask:0xf bank_mask:0xf
    s_nop 1
    v_max_f32_dpp v76, v76, v76 row_ror:1 row_mask:0xf bank_mask:0xf
    s_lshl_b32 s48, s4, 2
    s_add_u32 s48, s48, s7
    s_lshl_b32 s48, s48, 2
    s_add_u32 s48, s48, 131072
    v_mov_b32 v77, s48
    s_mov_b64 exec, 1
    buffer_store_dword v76, v77, s[16:19], 0 offen sc1
    s_mov_b64 exec, -1
    s_branch L_kvf_done
L_kvf_V:
    s_lshl_b32 s51, s50, 9
    s_add_u32 s49, s49, s51
    s_add_u32 s49, s49, 8192
    v_lshlrev_b32 v67, 8, v67
    v_add_u32 v67, v67, v65
    v_cvt_pk_bf16_f32 v72, v68, v69
    v_cvt_pk_bf16_f32 v73, v70, v71
    buffer_store_dwordx2 v[72:73], v67, s[16:19], s49 offen sc1
    s_waitcnt lgkmcnt(0)
    v_add_f32 v84, v84, v85
    v_add_f32 v86, v86, v87
    v_add_f32 v84, v84, v86
    v_mul_f32 v84, 0xbfb8aa3b, v84
    v_exp_f32 v84, v84
    s_nop 0
    v_add_f32 v84, 1.0, v84
    v_rcp_f32 v84, v84
    s_lshl_b32 s48, s4, 2
    s_add_u32 s48, s48, s7
    s_lshl_b32 s48, s48, 7
    v_lshlrev_b32 v77, 2, v66
    s_add_u32 s49, s48, 180224
    s_mov_b64 exec, 0xffff
    buffer_store_dword v84, v77, s[16:19], s49 offen sc1
    s_mov_b64 exec, -1
L_kvf_done:
    s_nop 1
    s_add_u32 m0, s89, 49152
    s_add_u32 s70, s70, s71
    buffer_load_dwordx4 v31, s[12:15], s70 offen lds
    s_add_u32 m0, s89, 50176
    s_add_u32 s70, s70, s71
    buffer_load_dwordx4 v31, s[12:15], s70 offen lds
    s_add_u32 m0, s89, 51200
    s_add_u32 s70, s70, s71
    buffer_load_dwordx4 v31, s[12:15], s70 offen lds
    s_add_u32 m0, s89, 52224
    s_add_u32 s70, s70, s71
    buffer_load_dwordx4 v31, s[12:15], s70 offen lds
    s_waitcnt vmcnt(8)
    s_barrier
    s_lshr_b32 s70, s72, 1
    s_mul_i32 s70, s70, s53
    s_sub_u32 s70, s70, s71
    s_add_u32 m0, s89, 0
    s_add_u32 s70, s70, s71
    buffer_load_dwordx4 v31, s[12:15], s70 offen lds
    s_add_u32 m0, s89, 1024
    s_add_u32 s70, s70, s71
    buffer_load_dwordx4 v31, s[12:15], s70 offen lds
    s_add_u32 m0, s89, 2048
    s_add_u32 s70, s70, s71
    buffer_load_dwordx4 v31, s[12:15], s70 offen lds
    s_add_u32 m0, s89, 3072
    s_add_u32 s70, s70, s71
    buffer_load_dwordx4 v31, s[12:15], s70 offen lds
    s_waitcnt vmcnt(8)
    s_barrier
    s_add_u32 m0, s89, 16384
    s_add_u32 s70, s70, s71
    buffer_load_dwordx4 v31, s[12:15], s70 offen lds
    s_add_u32 m0, s89, 17408
    s_add_u32 s70, s70, s71
    buffer_load_dwordx4 v31, s[12:15], s70 offen lds
    s_add_u32 m0, s89, 18432
    s_add_u32 s70, s70, s71
    buffer_load_dwordx4 v31, s[12:15], s70 offen lds
    s_add_u32 m0, s89, 19456
    s_add_u32 s70, s70, s71
    buffer_load_dwordx4 v31, s[12:15], s70 offen lds
    s_waitcnt vmcnt(8)
    s_barrier
    s_add_u32 m0, s89, 32768
    s_add_u32 s70, s70, s71
    buffer_load_dwordx4 v31, s[12:15], s70 offen lds
    s_add_u32 m0, s89, 33792
    s_add_u32 s70, s70, s71
    buffer_load_dwordx4 v31, s[12:15], s70 offen lds
    s_add_u32 m0, s89, 34816
    s_add_u32 s70, s70, s71
    buffer_load_dwordx4 v31, s[12:15], s70 offen lds
    s_add_u32 m0, s89, 35840
    s_add_u32 s70, s70, s71
    buffer_load_dwordx4 v31, s[12:15], s70 offen lds
    s_waitcnt vmcnt(8)
    s_barrier
    s_add_u32 m0, s89, 49152
    s_add_u32 s70, s70, s71
    buffer_load_dwordx4 v31, s[12:15], s70 offen lds
    s_add_u32 m0, s89, 50176
    s_add_u32 s70, s70, s71
    buffer_load_dwordx4 v31, s[12:15], s70 offen lds
    s_add_u32 m0, s89, 51200
    s_add_u32 s70, s70, s71
    buffer_load_dwordx4 v31, s[12:15], s70 offen lds
    s_add_u32 m0, s89, 52224
    s_add_u32 s70, s70, s71
    buffer_load_dwordx4 v31, s[12:15], s70 offen lds
    s_waitcnt vmcnt(8)
    s_barrier
    s_lshr_b32 s70, s72, 1
    s_mul_i32 s70, s70, s54
    s_sub_u32 s70, s70, s71
    s_add_u32 m0, s89, 0
    s_add_u32 s70, s70, s71
    buffer_load_dwordx4 v31, s[12:15], s70 offen lds
    s_add_u32 m0, s89, 1024
    s_add_u32 s70, s70, s71
    buffer_load_dwordx4 v31, s[12:15], s70 offen lds
    s_add_u32 m0, s89, 2048
    s_add_u32 s70, s70, s71
    buffer_load_dwordx4 v31, s[12:15], s70 offen lds
    s_add_u32 m0, s89, 3072
    s_add_u32 s70, s70, s71
    buffer_load_dwordx4 v31, s[12:15], s70 offen lds
    s_waitcnt vmcnt(8)
    s_barrier
    s_add_u32 m0, s89, 16384
    s_add_u32 s70, s70, s71
    buffer_load_dwordx4 v31, s[12:15], s70 offen lds
    s_add_u32 m0, s89, 17408
    s_add_u32 s70, s70, s71
    buffer_load_dwordx4 v31, s[12:15], s70 offen lds
    s_add_u32 m0, s89, 18432
    s_add_u32 s70, s70, s71
    buffer_load_dwordx4 v31, s[12:15], s70 offen lds
    s_add_u32 m0, s89, 19456
    s_add_u32 s70, s70, s71
    buffer_load_dwordx4 v31, s[12:15], s70 offen lds
    s_waitcnt vmcnt(8)
    s_barrier
    s_add_u32 m0, s89, 32768
    s_add_u32 s70, s70, s71
    buffer_load_dwordx4 v31, s[12:15], s70 offen lds
    s_add_u32 m0, s89, 33792
    s_add_u32 s70, s70, s71
    buffer_load_dwordx4 v31, s[12:15], s70 offen lds
    s_add_u32 m0, s89, 34816
    s_add_u32 s70, s70, s71
    buffer_load_dwordx4 v31, s[12:15], s70 offen lds
    s_add_u32 m0, s89, 35840
    s_add_u32 s70, s70, s71
    buffer_load_dwordx4 v31, s[12:15], s70 offen lds
    s_waitcnt vmcnt(8)
    s_barrier
    s_add_u32 m0, s89, 49152
    s_add_u32 s70, s70, s71
    buffer_load_dwordx4 v31, s[12:15], s70 offen lds
    s_add_u32 m0, s89, 50176
    s_add_u32 s70, s70, s71
    buffer_load_dwordx4 v31, s[12:15], s70 offen lds
    s_add_u32 m0, s89, 51200
    s_add_u32 s70, s70, s71
    buffer_load_dwordx4 v31, s[12:15], s70 offen lds
    s_add_u32 m0, s89, 52224
    s_add_u32 s70, s70, s71
    buffer_load_dwordx4 v31, s[12:15], s70 offen lds
    s_waitcnt vmcnt(8)
    s_barrier
    s_lshr_b32 s70, s72, 1
    s_mul_i32 s70, s70, s55
    s_sub_u32 s70, s70, s71
    s_add_u32 m0, s89, 0
    s_add_u32 s70, s70, s71
    buffer_load_dwordx4 v31, s[12:15], s70 offen lds
    s_add_u32 m0, s89, 1024
    s_add_u32 s70, s70, s71
    buffer_load_dwordx4 v31, s[12:15], s70 offen lds
    s_add_u32 m0, s89, 2048
    s_add_u32 s70, s70, s71
    buffer_load_dwordx4 v31, s[12:15], s70 offen lds
    s_add_u32 m0, s89, 3072
    s_add_u32 s70, s70, s71
    buffer_load_dwordx4 v31, s[12:15], s70 offen lds
    s_waitcnt vmcnt(8)
    s_barrier
    s_cmp_lg_u32 s90, 0
    s_cbranch_scc1 L_sw_nopoll
    buffer_load_dword v9, v24, s[20:23], 0 offen sc1
L_sw_nopoll:
    s_add_u32 m0, s89, 16384
    s_add_u32 s70, s70, s71
    buffer_load_dwordx4 v31, s[12:15], s70 offen lds
    s_add_u32 m0, s89, 17408
    s_add_u32 s70, s70, s71
    buffer_load_dwordx4 v31, s[12:15], s70 offen lds
    s_add_u32 m0, s89, 18432
    s_add_u32 s70, s70, s71
    buffer_load_dwordx4 v31, s[12:15], s70 offen lds
    s_add_u32 m0, s89, 19456
    s_add_u32 s70, s70, s71
    buffer_load_dwordx4 v31, s[12:15], s70 offen lds
    s_waitcnt vmcnt(8)
    s_barrier
    s_add_u32 m0, s89, 32768
    s_add_u32 s70, s70, s71
    buffer_load_dwordx4 v31, s[12:15], s70 offen lds
    s_add_u32 m0, s89, 33792
    s_add_u32 s70, s70, s71
    buffer_load_dwordx4 v31, s[12:15], s70 offen lds
    s_add_u32 m0, s89, 34816
    s_add_u32 s70, s70, s71
    buffer_load_dwordx4 v31, s[12:15], s70 offen lds
    s_add_u32 m0, s89, 35840
    s_add_u32 s70, s70, s71
    buffer_load_dwordx4 v31, s[12:15], s70 offen lds
    s_waitcnt vmcnt(8)
    s_barrier
    s_add_u32 m0, s89, 49152
    s_add_u32 s70, s70, s71
    buffer_load_dwordx4 v31, s[12:15], s70 offen lds
    s_add_u32 m0, s89, 50176
    s_add_u32 s70, s70, s71
    buffer_load_dwordx4 v31, s[12:15], s70 offen lds
    s_add_u32 m0, s89, 51200
    s_add_u32 s70, s70, s71
    buffer_load_dwordx4 v31, s[12:15], s70 offen lds
    s_add_u32 m0, s89, 52224
    s_add_u32 s70, s70, s71
    buffer_load_dwordx4 v31, s[12:15], s70 offen lds
    s_waitcnt vmcnt(8)
    s_cmp_lg_u32 s90, 0
    s_cbranch_scc1 L_sw_nogo
    v_cmp_gt_u32 vcc, 64, v9
    s_cmp_eq_u64 vcc, 0
    s_cselect_b32 s48, 1, 0
    v_mov_b32 v9, s48
    ds_write_b32 v25, v9
    s_waitcnt lgkmcnt(0)
L_sw_nogo:
    s_barrier
    ds_read_b32 v9, v25
    s_waitcnt lgkmcnt(0)
    v_readfirstlane_b32 s69, v9
    s_cmp_eq_u32 s69, 1
    s_cbranch_scc0 L_sw_noearly
    s_lshl_b32 s49, s90, 13
    s_add_u32 s95, s49, s94
    s_add_u32 s95, s95, 0
    s_and_b32 s95, s95, 0x1ffff
    s_add_u32 m0, s49, 0
    s_nop 0
    buffer_load_dwordx4 v16, s[16:19], s95 offen offset:0 sc1 lds
    s_add_u32 m0, s49, 0
    s_nop 0
    buffer_load_dwordx4 v16, s[16:19], s95 offen offset:1024 sc1 lds
    s_add_u32 m0, s49, 0
    s_nop 0
    buffer_load_dwordx4 v16, s[16:19], s95 offen offset:2048 sc1 lds
    s_add_u32 m0, s49, 0
    s_nop 0
    buffer_load_dwordx4 v16, s[16:19], s95 offen offset:3072 sc1 lds
    s_add_u32 s95, s49, s94
    s_add_u32 s95, s95, 4096
    s_and_b32 s95, s95, 0x1ffff
    s_add_u32 m0, s49, 4096
    s_nop 0
    buffer_load_dwordx4 v16, s[16:19], s95 offen offset:0 sc1 lds
    s_add_u32 m0, s49, 4096
    s_nop 0
    buffer_load_dwordx4 v16, s[16:19], s95 offen offset:1024 sc1 lds
    s_add_u32 m0, s49, 4096
    s_nop 0
    buffer_load_dwordx4 v16, s[16:19], s95 offen offset:2048 sc1 lds
    s_add_u32 m0, s49, 4096
    s_nop 0
    buffer_load_dwordx4 v16, s[16:19], s95 offen offset:3072 sc1 lds
    v_lshlrev_b32 v8, 3, v1
    s_mov_b32 s48, 131072
    buffer_load_dwordx2 v[26:27], v8, s[16:19], s48 offen sc1
L_sw_noearly:
    s_cmp_eq_u32 s69, 1
    s_cbranch_scc1 L_sw_w14
    s_waitcnt vmcnt(4)
L_sw_w14:
    s_waitcnt vmcnt(13)
    s_barrier
    s_cmp_eq_u32 s69, 1
    s_cbranch_scc1 L_sw_w15
    s_waitcnt vmcnt(0)
L_sw_w15:
    s_waitcnt vmcnt(9)
    s_barrier
    s_cmp_eq_u32 s69, 1
    s_cbranch_scc1 L_sw_have
    s_mov_b32 s50, 0
    s_cmp_lg_u32 s90, 0
    s_cbranch_scc1 L_poll_lds
L_poll_go:
    buffer_load_dword v9, v24, s[20:23], 0 offen sc1
    s_add_u32 s50, s50, 1
    s_waitcnt vmcnt(0)
    v_cmp_gt_u32 vcc, 64, v9
    s_cmp_ge_u32 s50, 32768
    s_cbranch_scc1 L_poll_set
    s_cbranch_vccz L_poll_set
    s_sleep 8
    s_branch L_poll_go
L_poll_set:
    v_mov_b32 v9, 1
    ds_write_b32 v25, v9
    s_branch L_poll_go_done
L_poll_lds:
    ds_read_b32 v9, v25
    s_add_u32 s50, s50, 1
    s_waitcnt lgkmcnt(0)
    v_readfirstlane_b32 s48, v9
    s_cmp_ge_u32 s50, 1048576
    s_cbranch_scc1 L_poll_go_done
    s_cmp_eq_u32 s48, 1
    s_cbranch_scc1 L_poll_go_done
    s_sleep 1
    s_branch L_poll_lds
L_poll_go_done:
    s_lshl_b32 s49, s90, 13
    s_add_u32 s95, s49, s94
    s_add_u32 s95, s95, 0
    s_and_b32 s95, s95, 0x1ffff
    s_add_u32 m0, s49, 0
    s_nop 0
    buffer_load_dwordx4 v16, s[16:19], s95 offen offset:0 sc1 lds
    s_add_u32 m0, s49, 0
    s_nop 0
    buffer_load_dwordx4 v16, s[16:19], s95 offen offset:1024 sc1 lds
    s_add_u32 m0, s49, 0
    s_nop 0
    buffer_load_dwordx4 v16, s[16:19], s95 offen offset:2048 sc1 lds
    s_add_u32 m0, s49, 0
    s_nop 0
    buffer_load_dwordx4 v16, s[16:19], s95 offen offset:3072 sc1 lds
    s_add_u32 s95, s49, s94
    s_add_u32 s95, s95, 4096
    s_and_b32 s95, s95, 0x1ffff
    s_add_u32 m0, s49, 4096
    s_nop 0
    buffer_load_dwordx4 v16, s[16:19], s95 offen offset:0 sc1 lds
    s_add_u32 m0, s49, 4096
    s_nop 0
    buffer_load_dwordx4 v16, s[16:19], s95 offen offset:1024 sc1 lds
    s_add_u32 m0, s49, 4096
    s_nop 0
    buffer_load_dwordx4 v16, s[16:19], s95 offen offset:2048 sc1 lds
    s_add_u32 m0, s49, 4096
    s_nop 0
    buffer_load_dwordx4 v16, s[16:19], s95 offen offset:3072 sc1 lds
    v_lshlrev_b32 v8, 3, v1
    s_mov_b32 s48, 131072
    buffer_load_dwordx2 v[26:27], v8, s[16:19], s48 offen sc1
L_sw_have:
    s_waitcnt vmcnt(0)
    v_max_f32 v26, v26, v27
    v_mov_b32 v27, v26
    s_nop 1
    v_permlane32_swap_b32 v26, v27
    v_max_f32 v26, v26, v27
    v_mov_b32 v27, v26
    s_nop 1
    v_permlane16_swap_b32 v26, v27
    v_max_f32 v26, v26, v27
    s_nop 1
    v_max_f32_dpp v26, v26, v26 row_ror:8 row_mask:0xf bank_mask:0xf
    s_nop 1
    v_max_f32_dpp v26, v26, v26 row_ror:4 row_mask:0xf bank_mask:0xf
    s_nop 1
    v_max_f32_dpp v26, v26, v26 row_ror:2 row_mask:0xf bank_mask:0xf
    s_nop 1
    v_max_f32_dpp v26, v26, v26 row_ror:1 row_mask:0xf bank_mask:0xf
    v_mov_b32 v27, 129024
    ds_write_b32 v27, v26
    s_waitcnt lgkmcnt(0)
    s_setprio 3
    s_barrier
    s_add_u32 s95, s94, 32768
    s_and_b32 s95, s95, 0x1ffff
    s_add_u32 s95, s95, s96
    s_add_u32 m0, s96, 32768
    s_nop 0
    buffer_load_dwordx4 v16, s[16:19], s95 offen offset:0 sc1 lds
    s_add_u32 m0, s96, 32768
    s_nop 0
    buffer_load_dwordx4 v16, s[16:19], s95 offen offset:1024 sc1 lds
    s_add_u32 m0, s96, 32768
    s_nop 0
    buffer_load_dwordx4 v16, s[16:19], s95 offen offset:2048 sc1 lds
    s_add_u32 m0, s96, 32768
    s_nop 0
    buffer_load_dwordx4 v16, s[16:19], s95 offen offset:3072 sc1 lds
    s_mov_b32 s51, 0x3eb8aa3b
    ds_read_b128 v[32:35], v152 offset:0
    ds_read_b128 v[36:39], v152 offset:2560
    s_mov_b64 exec, s[80:81]
    ds_read_b128 v[48:51], v153 offset:0
    ds_read_b128 v[52:55], v153 offset:2560
    s_mov_b64 exec, -1
    ds_read_b64_tr_b16 v[64:65], v154 offset:0
    ds_read_b64_tr_b16 v[66:67], v154 offset:32
    ds_read_b64_tr_b16 v[68:69], v154 offset:2560
    ds_read_b64_tr_b16 v[70:71], v154 offset:2592
    s_waitcnt lgkmcnt(4)
    v_mfma_f32_16x16x32_bf16 v[72:75], v[32:35], v[48:51], v[156:159]
    v_mfma_f32_16x16x32_bf16 v[76:79], v[36:39], v[52:55], v[156:159]
    s_nop 6
    v_max3_f32 v96, v72, v73, v74
    v_max_f32 v96, v96, v75
    v_mov_b32 v97, v96
    v_max3_f32 v98, v76, v77, v78
    v_max_f32 v98, v98, v79
    v_mov_b32 v99, v98
    v_permlane32_swap_b32 v96, v97
    s_nop 0
    v_permlane32_swap_b32 v98, v99
    v_max_f32 v96, v96, v97
    v_mov_b32 v97, v96
    v_max_f32 v98, v98, v99
    v_mov_b32 v99, v98
    v_permlane16_swap_b32 v96, v97
    s_nop 0
    v_permlane16_swap_b32 v98, v99
    v_max_f32 v96, v96, v97
    v_mul_f32 v96, s51, v96
    v_max_f32 v98, v98, v99
    v_mul_f32 v98, s51, v98
    v_fma_f32 v72, v72, s51, -v96
    v_fma_f32 v73, v73, s51, -v96
    v_fma_f32 v74, v74, s51, -v96
    v_fma_f32 v75, v75, s51, -v96
    v_fma_f32 v76, v76, s51, -v98
    v_fma_f32 v77, v77, s51, -v98
    v_fma_f32 v78, v78, s51, -v98
    v_fma_f32 v79, v79, s51, -v98
    v_exp_f32 v72, v72
    v_exp_f32 v73, v73
    v_exp_f32 v74, v74
    v_exp_f32 v75, v75
    v_exp_f32 v76, v76
    v_exp_f32 v77, v77
    v_exp_f32 v78, v78
    v_exp_f32 v79, v79
    s_mov_b64 exec, s[82:83]
    v_cvt_pk_bf16_f32 v56, v72, v73
    v_cvt_pk_bf16_f32 v57, v74, v75
    v_cvt_pk_bf16_f32 v60, v76, v77
    v_cvt_pk_bf16_f32 v61, v78, v79
    s_mov_b64 exec, s[84:85]
    v_cvt_pk_bf16_f32 v58, v72, v73
    v_cvt_pk_bf16_f32 v59, v74, v75
    v_cvt_pk_bf16_f32 v62, v76, v77
    v_cvt_pk_bf16_f32 v63, v78, v79
    s_mov_b64 exec, -1
    s_waitcnt lgkmcnt(0)
    v_mfma_f32_16x16x32_bf16 v[88:91], v[160:163], v[56:59], 0
    v_mfma_f32_16x16x32_bf16 v[92:95], v[160:163], v[60:63], 0
    v_mfma_f32_16x16x32_bf16 v[80:83], v[64:67], v[56:59], 0
    v_mfma_f32_16x16x32_bf16 v[84:87], v[68:71], v[60:63], 0
    s_nop 4
    v_rcp_f32 v88, v88
    v_rcp_f32 v92, v92
    v_mul_f32 v80, v80, v88
    v_mul_f32 v81, v81, v88
    v_mul_f32 v82, v82, v88
    v_mul_f32 v83, v83, v88
    v_cvt_pk_bf16_f32 v80, v80, v81
    v_cvt_pk_bf16_f32 v81, v82, v83
    ds_write_b64 v155, v[80:81] offset:0
    v_mul_f32 v84, v84, v92
    v_mul_f32 v85, v85, v92
    v_mul_f32 v86, v86, v92
    v_mul_f32 v87, v87, v92
    v_cvt_pk_bf16_f32 v84, v84, v85
    v_cvt_pk_bf16_f32 v85, v86, v87
    ds_write_b64 v155, v[84:85] offset:32
    ds_read_b128 v[32:35], v152 offset:5120
    ds_read_b128 v[36:39], v152 offset:7680
    s_mov_b64 exec, s[80:81]
    ds_read_b128 v[48:51], v153 offset:5120
    ds_read_b128 v[52:55], v153 offset:7680
    s_mov_b64 exec, -1
    ds_read_b64_tr_b16 v[64:65], v154 offset:5120
    ds_read_b64_tr_b16 v[66:67], v154 offset:5152
    ds_read_b64_tr_b16 v[68:69], v154 offset:7680
    ds_read_b64_tr_b16 v[70:71], v154 offset:7712
    s_waitcnt lgkmcnt(4)
    v_mfma_f32_16x16x32_bf16 v[72:75], v[32:35], v[48:51], v[156:159]
    v_mfma_f32_16x16x32_bf16 v[76:79], v[36:39], v[52:55], v[156:159]
    s_nop 6
    v_max3_f32 v96, v72, v73, v74
    v_max_f32 v96, v96, v75
    v_mov_b32 v97, v96
    v_max3_f32 v98, v76, v77, v78
    v_max_f32 v98, v98, v79
    v_mov_b32 v99, v98
    v_permlane32_swap_b32 v96, v97
    s_nop 0
    v_permlane32_swap_b32 v98, v99
    v_max_f32 v96, v96, v97
    v_mov_b32 v97, v96
    v_max_f32 v98, v98, v99
    v_mov_b32 v99, v98
    v_permlane16_swap_b32 v96, v97
    s_nop 0
    v_permlane16_swap_b32 v98, v99
    v_max_f32 v96, v96, v97
    v_mul_f32 v96, s51, v96
    v_max_f32 v98, v98, v99
    v_mul_f32 v98, s51, v98
    v_fma_f32 v72, v72, s51, -v96
    v_fma_f32 v73, v73, s51, -v96
    v_fma_f32 v74, v74, s51, -v96
    v_fma_f32 v75, v75, s51, -v96
    v_fma_f32 v76, v76, s51, -v98
    v_fma_f32 v77, v77, s51, -v98
    v_fma_f32 v78, v78, s51, -v98
    v_fma_f32 v79, v79, s51, -v98
    v_exp_f32 v72, v72
    v_exp_f32 v73, v73
    v_exp_f32 v74, v74
    v_exp_f32 v75, v75
    v_exp_f32 v76, v76
    v_exp_f32 v77, v77
    v_exp_f32 v78, v78
    v_exp_f32 v79, v79
    s_mov_b64 exec, s[82:83]
    v_cvt_pk_bf16_f32 v56, v72, v73
    v_cvt_pk_bf16_f32 v57, v74, v75
    v_cvt_pk_bf16_f32 v60, v76, v77
    v_cvt_pk_bf16_f32 v61, v78, v79
    s_mov_b64 exec, s[84:85]
    v_cvt_pk_bf16_f32 v58, v72, v73
    v_cvt_pk_bf16_f32 v59, v74, v75
    v_cvt_pk_bf16_f32 v62, v76, v77
    v_cvt_pk_bf16_f32 v63, v78, v79
    s_mov_b64 exec, -1
    s_waitcnt lgkmcnt(0)
    v_mfma_f32_16x16x32_bf16 v[88:91], v[160:163], v[56:59], 0
    v_mfma_f32_16x16x32_bf16 v[92:95], v[160:163], v[60:63], 0
    v_mfma_f32_16x16x32_bf16 v[80:83], v[64:67], v[56:59], 0
    v_mfma_f32_16x16x32_bf16 v[84:87], v[68:71], v[60:63], 0
    s_nop 4
    v_rcp_f32 v88, v88
    v_rcp_f32 v92, v92
    v_mul_f32 v80, v80, v88
    v_mul_f32 v81, v81, v88
    v_mul_f32 v82, v82, v88
    v_mul_f32 v83, v83, v88
    v_cvt_pk_bf16_f32 v80, v80, v81
    v_cvt_pk_bf16_f32 v81, v82, v83
    ds_write_b64 v155, v[80:81] offset:64
    v_mul_f32 v84, v84, v92
    v_mul_f32 v85, v85, v92
    v_mul_f32 v86, v86, v92
    v_mul_f32 v87, v87, v92
    v_cvt_pk_bf16_f32 v84, v84, v85
    v_cvt_pk_bf16_f32 v85, v86, v87
    ds_write_b64 v155, v[84:85] offset:96
    s_waitcnt lgkmcnt(0)
    ds_read_b128 v[32:35], v166
    ds_read_b128 v[36:39], v166 offset:1024
    s_add_u32 s49, s74, 3145728
    s_add_u32 s50, s74, 3153920
    s_add_u32 s51, s74, 1056768
    s_add_u32 s48, s74, 1048576
    v_mov_b32 v40, -1
    v_mov_b32 v41, -1
    v_mov_b32 v42, -1
    v_mov_b32 v43, -1
    buffer_store_dwordx4 v[40:43], v164, s[16:19], s49 offen sc1
    buffer_store_dwordx4 v[40:43], v164, s[16:19], s50 offen sc1
    s_waitcnt lgkmcnt(0)
    buffer_store_dwordx4 v[32:35], v164, s[16:19], s48 offen sc1
    buffer_store_dwordx4 v[36:39], v164, s[16:19], s51 offen sc1
    buffer_load_dword v24, v165, s[16:19], s75 offen sc1
    buffer_load_dword v25, v165, s[16:19], s75 offen offset:256 sc1
    v_mov_b32 v26, v166
    s_waitcnt vmcnt(6)
    s_setprio 3
    s_barrier
    s_add_u32 s95, s94, 49152
    s_and_b32 s95, s95, 0x1ffff
    s_add_u32 s95, s95, s96
    s_add_u32 m0, s96, 0
    s_nop 0
    buffer_load_dwordx4 v16, s[16:19], s95 offen offset:0 sc1 lds
    s_add_u32 m0, s96, 0
    s_nop 0
    buffer_load_dwordx4 v16, s[16:19], s95 offen offset:1024 sc1 lds
    s_add_u32 m0, s96, 0
    s_nop 0
    buffer_load_dwordx4 v16, s[16:19], s95 offen offset:2048 sc1 lds
    s_add_u32 m0, s96, 0
    s_nop 0
    buffer_load_dwordx4 v16, s[16:19], s95 offen offset:3072 sc1 lds
    s_add_u32 m0, s78, 0
    s_add_u32 s95, s79, 0
    buffer_load_dwordx4 v30, s[36:39], s95 offen lds
    s_add_u32 m0, s78, 1024
    s_add_u32 s95, s79, 8192
    buffer_load_dwordx4 v30, s[36:39], s95 offen lds
    s_add_u32 m0, s78, 2048
    s_add_u32 s95, s79, 16384
    buffer_load_dwordx4 v30, s[36:39], s95 offen lds
    s_add_u32 m0, s78, 3072
    s_add_u32 s95, s79, 24576
    buffer_load_dwordx4 v30, s[36:39], s95 offen lds
    s_add_u32 m0, s78, 4096
    s_add_u32 s95, s79, 32768
    buffer_load_dwordx4 v30, s[36:39], s95 offen lds
    s_add_u32 m0, s78, 5120
    s_add_u32 s95, s79, 40960
    buffer_load_dwordx4 v30, s[36:39], s95 offen lds
    s_add_u32 m0, s78, 6144
    s_add_u32 s95, s79, 49152
    buffer_load_dwordx4 v30, s[36:39], s95 offen lds
    s_add_u32 m0, s78, 7168
    s_add_u32 s95, s79, 57344
    buffer_load_dwordx4 v30, s[36:39], s95 offen lds
    s_add_u32 m0, s78, 8192
    s_add_u32 s95, s79, 65536
    buffer_load_dwordx4 v30, s[36:39], s95 offen lds
    s_add_u32 m0, s78, 9216
    s_add_u32 s95, s79, 73728
    buffer_load_dwordx4 v30, s[36:39], s95 offen lds
    s_add_u32 m0, s78, 10240
    s_add_u32 s95, s79, 81920
    buffer_load_dwordx4 v30, s[36:39], s95 offen lds
    s_add_u32 m0, s78, 11264
    s_add_u32 s95, s79, 90112
    buffer_load_dwordx4 v30, s[36:39], s95 offen lds
    s_add_u32 m0, s78, 12288
    s_add_u32 s95, s79, 98304
    buffer_load_dwordx4 v30, s[36:39], s95 offen lds
    s_add_u32 m0, s78, 13312
    s_add_u32 s95, s79, 106496
    buffer_load_dwordx4 v30, s[36:39], s95 offen lds
    s_add_u32 m0, s78, 14336
    s_add_u32 s95, s79, 114688
    buffer_load_dwordx4 v30, s[36:39], s95 offen lds
    s_add_u32 m0, s78, 15360
    s_add_u32 s95, s79, 122880
    buffer_load_dwordx4 v30, s[36:39], s95 offen lds
    s_waitcnt vmcnt(16)
    s_barrier
    s_cmp_lg_u32 s90, 0
    s_cbranch_scc1 L_nopub
    s_lshl_b32 s48, s88, 7
    s_add_u32 s48, s48, 147460
    v_mov_b32 v12, s48
    v_mov_b32 v13, 1
    s_mov_b64 exec, 1
    buffer_store_dword v13, v12, s[16:19], 0 offen sc1
    s_mov_b64 exec, -1
L_nopub:
    s_add_u32 s95, s94, 65536
    s_and_b32 s95, s95, 0x1ffff
    s_add_u32 s95, s95, s96
    s_add_u32 m0, s96, 16384
    s_nop 0
    buffer_load_dwordx4 v16, s[16:19], s95 offen offset:0 sc1 lds
    s_add_u32 m0, s96, 16384
    s_nop 0
    buffer_load_dwordx4 v16, s[16:19], s95 offen offset:1024 sc1 lds
    s_add_u32 m0, s96, 16384
    s_nop 0
    buffer_load_dwordx4 v16, s[16:19], s95 offen offset:2048 sc1 lds
    s_add_u32 m0, s96, 16384
    s_nop 0
    buffer_load_dwordx4 v16, s[16:19], s95 offen offset:3072 sc1 lds
    s_waitcnt vmcnt(4)
    ds_read_b64_tr_b16 v[100:101], v2 offset:0
    ds_read_b64_tr_b16 v[102:103], v2 offset:1024
    ds_read_b64_tr_b16 v[104:105], v3 offset:0
    ds_read_b64_tr_b16 v[106:107], v3 offset:1024
    ds_read_b64_tr_b16 v[108:109], v2 offset:2048
    ds_read_b64_tr_b16 v[110:111], v2 offset:3072
    ds_read_b64_tr_b16 v[112:113], v3 offset:2048
    ds_read_b64_tr_b16 v[114:115], v3 offset:3072
    s_waitcnt lgkmcnt(0)
    ds_read_b64_tr_b16 v[116:117], v2 offset:4096
    ds_read_b64_tr_b16 v[118:119], v2 offset:5120
    ds_read_b64_tr_b16 v[120:121], v3 offset:4096
    ds_read_b64_tr_b16 v[122:123], v3 offset:5120
    ds_read_b64_tr_b16 v[124:125], v2 offset:6144
    ds_read_b64_tr_b16 v[126:127], v2 offset:7168
    ds_read_b64_tr_b16 v[128:129], v3 offset:6144
    ds_read_b64_tr_b16 v[130:131], v3 offset:7168
    s_waitcnt lgkmcnt(0)
    ds_read_b64_tr_b16 v[132:133], v2 offset:8192
    ds_read_b64_tr_b16 v[134:135], v2 offset:9216
    ds_read_b64_tr_b16 v[136:137], v3 offset:8192
    ds_read_b64_tr_b16 v[138:139], v3 offset:9216
    ds_read_b64_tr_b16 v[140:141], v2 offset:10240
    ds_read_b64_tr_b16 v[142:143], v2 offset:11264
    ds_read_b64_tr_b16 v[144:145], v3 offset:10240
    ds_read_b64_tr_b16 v[146:147], v3 offset:11264
    s_waitcnt lgkmcnt(0)
    ds_read_b64_tr_b16 v[148:149], v2 offset:12288
    ds_read_b64_tr_b16 v[150:151], v2 offset:13312
    ds_read_b64_tr_b16 v[152:153], v3 offset:12288
    ds_read_b64_tr_b16 v[154:155], v3 offset:13312
    ds_read_b64_tr_b16 v[156:157], v2 offset:14336
    ds_read_b64_tr_b16 v[158:159], v2 offset:15360
    ds_read_b64_tr_b16 v[160:161], v3 offset:14336
    ds_read_b64_tr_b16 v[162:163], v3 offset:15360
    s_waitcnt lgkmcnt(0)
    s_add_u32 m0, s78, 0
    s_add_u32 s95, s79, 0
    buffer_load_dwordx4 v30, s[32:35], s95 offen lds
    s_add_u32 m0, s78, 1024
    s_add_u32 s95, s79, 8192
    buffer_load_dwordx4 v30, s[32:35], s95 offen lds
    s_add_u32 m0, s78, 2048
    s_add_u32 s95, s79, 16384
    buffer_load_dwordx4 v30, s[32:35], s95 offen lds
    s_add_u32 m0, s78, 3072
    s_add_u32 s95, s79, 24576
    buffer_load_dwordx4 v30, s[32:35], s95 offen lds
    s_add_u32 m0, s78, 4096
    s_add_u32 s95, s79, 32768
    buffer_load_dwordx4 v30, s[32:35], s95 offen lds
    s_add_u32 m0, s78, 5120
    s_add_u32 s95, s79, 40960
    buffer_load_dwordx4 v30, s[32:35], s95 offen lds
    s_add_u32 m0, s78, 6144
    s_add_u32 s95, s79, 49152
    buffer_load_dwordx4 v30, s[32:35], s95 offen lds
    s_add_u32 m0, s78, 7168
    s_add_u32 s95, s79, 57344
    buffer_load_dwordx4 v30, s[32:35], s95 offen lds
    s_waitcnt vmcnt(8)
    s_barrier
    s_add_u32 s95, s94, 81920
    s_and_b32 s95, s95, 0x1ffff
    s_add_u32 s95, s95, s96
    s_add_u32 m0, s96, 32768
    s_nop 0
    buffer_load_dwordx4 v16, s[16:19], s95 offen offset:0 sc1 lds
    s_add_u32 m0, s96, 32768
    s_nop 0
    buffer_load_dwordx4 v16, s[16:19], s95 offen offset:1024 sc1 lds
    s_add_u32 m0, s96, 32768
    s_nop 0
    buffer_load_dwordx4 v16, s[16:19], s95 offen offset:2048 sc1 lds
    s_add_u32 m0, s96, 32768
    s_nop 0
    buffer_load_dwordx4 v16, s[16:19], s95 offen offset:3072 sc1 lds
    s_mov_b32 s49, 0
    s_mov_b32 s50, 147460
L_ap_poll:
    buffer_load_dword v12, v28, s[16:19], s50 offen sc1
    s_add_u32 s49, s49, 1
    s_waitcnt vmcnt(0)
    v_cmp_ne_u32 vcc, 1, v12
    s_cmp_ge_u32 s49, 32768
    s_cbranch_scc1 L_ap_go
    s_cbranch_vccz L_ap_go
    s_sleep 4
    s_branch L_ap_poll
L_ap_go:
    s_add_u32 m0, s78, 8192
    s_add_u32 s95, s86, 1048576
    buffer_load_dwordx4 v20, s[16:19], s95 offen sc1 lds
    s_add_u32 m0, s78, 9216
    s_add_u32 s95, s86, 1048576
    buffer_load_dwordx4 v21, s[16:19], s95 offen sc1 lds
    s_add_u32 m0, s78, 10240
    s_add_u32 s95, s86, 1048576
    buffer_load_dwordx4 v22, s[16:19], s95 offen sc1 lds
    s_add_u32 m0, s78, 11264
    s_add_u32 s95, s86, 1048576
    buffer_load_dwordx4 v23, s[16:19], s95 offen sc1 lds
    s_add_u32 m0, s78, 12288
    s_add_u32 s95, s86, 1081344
    buffer_load_dwordx4 v20, s[16:19], s95 offen sc1 lds
    s_add_u32 m0, s78, 13312
    s_add_u32 s95, s86, 1081344
    buffer_load_dwordx4 v21, s[16:19], s95 offen sc1 lds
    s_add_u32 m0, s78, 14336
    s_add_u32 s95, s86, 1081344
    buffer_load_dwordx4 v22, s[16:19], s95 offen sc1 lds
    s_add_u32 m0, s78, 15360
    s_add_u32 s95, s86, 1081344
    buffer_load_dwordx4 v23, s[16:19], s95 offen sc1 lds
    s_barrier
    s_add_u32 s95, s94, 98304
    s_and_b32 s95, s95, 0x1ffff
    s_add_u32 s95, s95, s96
    s_add_u32 m0, s96, 0
    s_nop 0
    buffer_load_dwordx4 v16, s[16:19], s95 offen offset:0 sc1 lds
    s_add_u32 m0, s96, 0
    s_nop 0
    buffer_load_dwordx4 v16, s[16:19], s95 offen offset:1024 sc1 lds
    s_add_u32 m0, s96, 0
    s_nop 0
    buffer_load_dwordx4 v16, s[16:19], s95 offen offset:2048 sc1 lds
    s_add_u32 m0, s96, 0
    s_nop 0
    buffer_load_dwordx4 v16, s[16:19], s95 offen offset:3072 sc1 lds
    s_waitcnt vmcnt(4)
    ds_read_b64_tr_b16 v[8:9], v2 offset:0
    ds_read_b64_tr_b16 v[10:11], v2 offset:1024
    ds_read_b64_tr_b16 v[12:13], v3 offset:0
    ds_read_b64_tr_b16 v[14:15], v3 offset:1024
    ds_read_b128 v[32:35], v4 offset:8192
    ds_read_b128 v[164:167], v4 offset:12288
    s_waitcnt lgkmcnt(0)
    v_mfma_f32_32x32x16_bf16 v[36:51], v[8:11], v[32:35], 0
    v_mfma_f32_32x32x16_bf16 v[52:67], v[8:11], v[164:167], 0
    v_mfma_f32_32x32x16_bf16 v[68:83], v[12:15], v[32:35], 0
    v_mfma_f32_32x32x16_bf16 v[84:99], v[12:15], v[164:167], 0
    ds_read_b64_tr_b16 v[8:9], v2 offset:2048
    ds_read_b64_tr_b16 v[10:11], v2 offset:3072
    ds_read_b64_tr_b16 v[12:13], v3 offset:2048
    ds_read_b64_tr_b16 v[14:15], v3 offset:3072
    ds_read_b128 v[32:35], v5 offset:8192
    ds_read_b128 v[164:167], v5 offset:12288
    s_waitcnt lgkmcnt(0)
    v_mfma_f32_32x32x16_bf16 v[36:51], v[8:11], v[32:35], v[36:51]
    v_mfma_f32_32x32x16_bf16 v[52:67], v[8:11], v[164:167], v[52:67]
    v_mfma_f32_32x32x16_bf16 v[68:83], v[12:15], v[32:35], v[68:83]
    v_mfma_f32_32x32x16_bf16 v[84:99], v[12:15], v[164:167], v[84:99]
    ds_read_b64_tr_b16 v[8:9], v2 offset:4096
    ds_read_b64_tr_b16 v[10:11], v2 offset:5120
    ds_read_b64_tr_b16 v[12:13], v3 offset:4096
    ds_read_b64_tr_b16 v[14:15], v3 offset:5120
    ds_read_b128 v[32:35], v6 offset:8192
    ds_read_b128 v[164:167], v6 offset:12288
    s_waitcnt lgkmcnt(0)
    v_mfma_f32_32x32x16_bf16 v[36:51], v[8:11], v[32:35], v[36:51]
    v_mfma_f32_32x32x16_bf16 v[52:67], v[8:11], v[164:167], v[52:67]
    v_mfma_f32_32x32x16_bf16 v[68:83], v[12:15], v[32:35], v[68:83]
    v_mfma_f32_32x32x16_bf16 v[84:99], v[12:15], v[164:167], v[84:99]
    ds_read_b64_tr_b16 v[8:9], v2 offset:6144
    ds_read_b64_tr_b16 v[10:11], v2 offset:7168
    ds_read_b64_tr_b16 v[12:13], v3 offset:6144
    ds_read_b64_tr_b16 v[14:15], v3 offset:7168
    ds_read_b128 v[32:35], v7 offset:8192
    ds_read_b128 v[164:167], v7 offset:12288
    s_waitcnt lgkmcnt(0)
    v_mfma_f32_32x32x16_bf16 v[36:51], v[8:11], v[32:35], v[36:51]
    v_mfma_f32_32x32x16_bf16 v[52:67], v[8:11], v[164:167], v[52:67]
    v_mfma_f32_32x32x16_bf16 v[68:83], v[12:15], v[32:35], v[68:83]
    v_mfma_f32_32x32x16_bf16 v[84:99], v[12:15], v[164:167], v[84:99]
    s_add_u32 m0, s78, 0
    s_add_u32 s95, s79, 65536
    buffer_load_dwordx4 v30, s[32:35], s95 offen lds
    s_add_u32 m0, s78, 1024
    s_add_u32 s95, s79, 73728
    buffer_load_dwordx4 v30, s[32:35], s95 offen lds
    s_add_u32 m0, s78, 2048
    s_add_u32 s95, s79, 81920
    buffer_load_dwordx4 v30, s[32:35], s95 offen lds
    s_add_u32 m0, s78, 3072
    s_add_u32 s95, s79, 90112
    buffer_load_dwordx4 v30, s[32:35], s95 offen lds
    s_add_u32 m0, s78, 4096
    s_add_u32 s95, s79, 98304
    buffer_load_dwordx4 v30, s[32:35], s95 offen lds
    s_add_u32 m0, s78, 5120
    s_add_u32 s95, s79, 106496
    buffer_load_dwordx4 v30, s[32:35], s95 offen lds
    s_add_u32 m0, s78, 6144
    s_add_u32 s95, s79, 114688
    buffer_load_dwordx4 v30, s[32:35], s95 offen lds
    s_add_u32 m0, s78, 7168
    s_add_u32 s95, s79, 122880
    buffer_load_dwordx4 v30, s[32:35], s95 offen lds
    s_add_u32 m0, s78, 8192
    s_add_u32 s95, s86, 1048704
    buffer_load_dwordx4 v20, s[16:19], s95 offen sc1 lds
    s_add_u32 m0, s78, 9216
    s_add_u32 s95, s86, 1048704
    buffer_load_dwordx4 v21, s[16:19], s95 offen sc1 lds
    s_add_u32 m0, s78, 10240
    s_add_u32 s95, s86, 1048704
    buffer_load_dwordx4 v22, s[16:19], s95 offen sc1 lds
    s_add_u32 m0, s78, 11264
    s_add_u32 s95, s86, 1048704
    buffer_load_dwordx4 v23, s[16:19], s95 offen sc1 lds
    s_add_u32 m0, s78, 12288
    s_add_u32 s95, s86, 1081472
    buffer_load_dwordx4 v20, s[16:19], s95 offen sc1 lds
    s_add_u32 m0, s78, 13312
    s_add_u32 s95, s86, 1081472
    buffer_load_dwordx4 v21, s[16:19], s95 offen sc1 lds
    s_add_u32 m0, s78, 14336
    s_add_u32 s95, s86, 1081472
    buffer_load_dwordx4 v22, s[16:19], s95 offen sc1 lds
    s_add_u32 m0, s78, 15360
    s_add_u32 s95, s86, 1081472
    buffer_load_dwordx4 v23, s[16:19], s95 offen sc1 lds
    s_waitcnt vmcnt(16)
    s_barrier
    s_add_u32 s95, s94, 114688
    s_and_b32 s95, s95, 0x1ffff
    s_add_u32 s95, s95, s96
    s_add_u32 m0, s96, 16384
    s_nop 0
    buffer_load_dwordx4 v16, s[16:19], s95 offen offset:0 sc1 lds
    s_add_u32 m0, s96, 16384
    s_nop 0
    buffer_load_dwordx4 v16, s[16:19], s95 offen offset:1024 sc1 lds
    s_add_u32 m0, s96, 16384
    s_nop 0
    buffer_load_dwordx4 v16, s[16:19], s95 offen offset:2048 sc1 lds
    s_add_u32 m0, s96, 16384
    s_nop 0
    buffer_load_dwordx4 v16, s[16:19], s95 offen offset:3072 sc1 lds
    s_waitcnt vmcnt(0)
    s_barrier
    s_barrier
    ds_read_b64_tr_b16 v[8:9], v2 offset:0
    ds_read_b64_tr_b16 v[10:11], v2 offset:1024
    ds_read_b64_tr_b16 v[12:13], v3 offset:0
    ds_read_b64_tr_b16 v[14:15], v3 offset:1024
    ds_read_b128 v[32:35], v4 offset:8192
    ds_read_b128 v[164:167], v4 offset:12288
    s_waitcnt lgkmcnt(0)
    v_mfma_f32_32x32x16_bf16 v[36:51], v[8:11], v[32:35], v[36:51]
    v_mfma_f32_32x32x16_bf16 v[52:67], v[8:11], v[164:167], v[52:67]
    v_mfma_f32_32x32x16_bf16 v[68:83], v[12:15], v[32:35], v[68:83]
    v_mfma_f32_32x32x16_bf16 v[84:99], v[12:15], v[164:167], v[84:99]
    ds_read_b64_tr_b16 v[8:9], v2 offset:2048
    ds_read_b64_tr_b16 v[10:11], v2 offset:3072
    ds_read_b64_tr_b16 v[12:13], v3 offset:2048
    ds_read_b64_tr_b16 v[14:15], v3 offset:3072
    ds_read_b128 v[32:35], v5 offset:8192
    ds_read_b128 v[164:167], v5 offset:12288
    s_waitcnt lgkmcnt(0)
    v_mfma_f32_32x32x16_bf16 v[36:51], v[8:11], v[32:35], v[36:51]
    v_mfma_f32_32x32x16_bf16 v[52:67], v[8:11], v[164:167], v[52:67]
    v_mfma_f32_32x32x16_bf16 v[68:83], v[12:15], v[32:35], v[68:83]
    v_mfma_f32_32x32x16_bf16 v[84:99], v[12:15], v[164:167], v[84:99]
    ds_read_b64_tr_b16 v[8:9], v2 offset:4096
    ds_read_b64_tr_b16 v[10:11], v2 offset:5120
    ds_read_b64_tr_b16 v[12:13], v3 offset:4096
    ds_read_b64_tr_b16 v[14:15], v3 offset:5120
    ds_read_b128 v[32:35], v6 offset:8192
    ds_read_b128 v[164:167], v6 offset:12288
    s_waitcnt lgkmcnt(0)
    v_mfma_f32_32x32x16_bf16 v[36:51], v[8:11], v[32:35], v[36:51]
    v_mfma_f32_32x32x16_bf16 v[52:67], v[8:11], v[164:167], v[52:67]
    v_mfma_f32_32x32x16_bf16 v[68:83], v[12:15], v[32:35], v[68:83]
    v_mfma_f32_32x32x16_bf16 v[84:99], v[12:15], v[164:167], v[84:99]
    ds_read_b64_tr_b16 v[8:9], v2 offset:6144
    ds_read_b64_tr_b16 v[10:11], v2 offset:7168
    ds_read_b64_tr_b16 v[12:13], v3 offset:6144
    ds_read_b64_tr_b16 v[14:15], v3 offset:7168
    ds_read_b128 v[32:35], v7 offset:8192
    ds_read_b128 v[164:167], v7 offset:12288
    s_waitcnt lgkmcnt(0)
    v_mfma_f32_32x32x16_bf16 v[36:51], v[8:11], v[32:35], v[36:51]
    v_mfma_f32_32x32x16_bf16 v[52:67], v[8:11], v[164:167], v[52:67]
    v_mfma_f32_32x32x16_bf16 v[68:83], v[12:15], v[32:35], v[68:83]
    v_mfma_f32_32x32x16_bf16 v[84:99], v[12:15], v[164:167], v[84:99]
    s_nop 11
    v_mul_f32 v36, v24, v36
    v_mul_f32 v37, v24, v37
    v_mul_f32 v38, v24, v38
    v_mul_f32 v39, v24, v39
    v_mul_f32 v40, v24, v40
    v_mul_f32 v41, v24, v41
    v_mul_f32 v42, v24, v42
    v_mul_f32 v43, v24, v43
    v_mul_f32 v44, v24, v44
    v_mul_f32 v45, v24, v45
    v_mul_f32 v46, v24, v46
    v_mul_f32 v47, v24, v47
    v_mul_f32 v48, v24, v48
    v_mul_f32 v49, v24, v49
    v_mul_f32 v50, v24, v50
    v_mul_f32 v51, v24, v51
    v_mul_f32 v52, v25, v52
    v_mul_f32 v53, v25, v53
    v_mul_f32 v54, v25, v54
    v_mul_f32 v55, v25, v55
    v_mul_f32 v56, v25, v56
    v_mul_f32 v57, v25, v57
    v_mul_f32 v58, v25, v58
    v_mul_f32 v59, v25, v59
    v_mul_f32 v60, v25, v60
    v_mul_f32 v61, v25, v61
    v_mul_f32 v62, v25, v62
    v_mul_f32 v63, v25, v63
    v_mul_f32 v64, v25, v64
    v_mul_f32 v65, v25, v65
    v_mul_f32 v66, v25, v66
    v_mul_f32 v67, v25, v67
    v_mul_f32 v68, v24, v68
    v_mul_f32 v69, v24, v69
    v_mul_f32 v70, v24, v70
    v_mul_f32 v71, v24, v71
    v_mul_f32 v72, v24, v72
    v_mul_f32 v73, v24, v73
    v_mul_f32 v74, v24, v74
    v_mul_f32 v75, v24, v75
    v_mul_f32 v76, v24, v76
    v_mul_f32 v77, v24, v77
    v_mul_f32 v78, v24, v78
    v_mul_f32 v79, v24, v79
    v_mul_f32 v80, v24, v80
    v_mul_f32 v81, v24, v81
    v_mul_f32 v82, v24, v82
    v_mul_f32 v83, v24, v83
    v_mul_f32 v84, v25, v84
    v_mul_f32 v85, v25, v85
    v_mul_f32 v86, v25, v86
    v_mul_f32 v87, v25, v87
    v_mul_f32 v88, v25, v88
    v_mul_f32 v89, v25, v89
    v_mul_f32 v90, v25, v90
    v_mul_f32 v91, v25, v91
    v_mul_f32 v92, v25, v92
    v_mul_f32 v93, v25, v93
    v_mul_f32 v94, v25, v94
    v_mul_f32 v95, v25, v95
    v_mul_f32 v96, v25, v96
    v_mul_f32 v97, v25, v97
    v_mul_f32 v98, v25, v98
    v_mul_f32 v99, v25, v99
    s_add_u32 m0, s78, 0
    s_add_u32 s95, s86, 3145728
    buffer_load_dwordx4 v20, s[16:19], s95 offen sc1 lds
    s_add_u32 m0, s78, 1024
    s_add_u32 s95, s86, 3145728
    buffer_load_dwordx4 v21, s[16:19], s95 offen sc1 lds
    s_add_u32 m0, s78, 2048
    s_add_u32 s95, s86, 3145728
    buffer_load_dwordx4 v22, s[16:19], s95 offen sc1 lds
    s_add_u32 m0, s78, 3072
    s_add_u32 s95, s86, 3145728
    buffer_load_dwordx4 v23, s[16:19], s95 offen sc1 lds
    s_add_u32 m0, s78, 4096
    s_add_u32 s95, s86, 3178496
    buffer_load_dwordx4 v20, s[16:19], s95 offen sc1 lds
    s_add_u32 m0, s78, 5120
    s_add_u32 s95, s86, 3178496
    buffer_load_dwordx4 v21, s[16:19], s95 offen sc1 lds
    s_add_u32 m0, s78, 6144
    s_add_u32 s95, s86, 3178496
    buffer_load_dwordx4 v22, s[16:19], s95 offen sc1 lds
    s_add_u32 m0, s78, 7168
    s_add_u32 s95, s86, 3178496
    buffer_load_dwordx4 v23, s[16:19], s95 offen sc1 lds
    s_add_u32 m0, s78, 8192
    s_add_u32 s95, s86, 3145856
    buffer_load_dwordx4 v20, s[16:19], s95 offen sc1 lds
    s_add_u32 m0, s78, 9216
    s_add_u32 s95, s86, 3145856
    buffer_load_dwordx4 v21, s[16:19], s95 offen sc1 lds
    s_add_u32 m0, s78, 10240
    s_add_u32 s95, s86, 3145856
    buffer_load_dwordx4 v22, s[16:19], s95 offen sc1 lds
    s_add_u32 m0, s78, 11264
    s_add_u32 s95, s86, 3145856
    buffer_load_dwordx4 v23, s[16:19], s95 offen sc1 lds
    s_add_u32 m0, s78, 12288
    s_add_u32 s95, s86, 3178624
    buffer_load_dwordx4 v20, s[16:19], s95 offen sc1 lds
    s_add_u32 m0, s78, 13312
    s_add_u32 s95, s86, 3178624
    buffer_load_dwordx4 v21, s[16:19], s95 offen sc1 lds
    s_add_u32 m0, s78, 14336
    s_add_u32 s95, s86, 3178624
    buffer_load_dwordx4 v22, s[16:19], s95 offen sc1 lds
    s_add_u32 m0, s78, 15360
    s_add_u32 s95, s86, 3178624
    buffer_load_dwordx4 v23, s[16:19], s95 offen sc1 lds
    s_mov_b32 s49, 0
    s_waitcnt vmcnt(8)
    s_branch L_t0f
L_t0r:
    s_sleep 4
    s_add_u32 m0, s78, 0
    s_add_u32 s95, s86, 3145728
    buffer_load_dwordx4 v20, s[16:19], s95 offen sc1 lds
    s_add_u32 m0, s78, 1024
    s_add_u32 s95, s86, 3145728
    buffer_load_dwordx4 v21, s[16:19], s95 offen sc1 lds
    s_add_u32 m0, s78, 2048
    s_add_u32 s95, s86, 3145728
    buffer_load_dwordx4 v22, s[16:19], s95 offen sc1 lds
    s_add_u32 m0, s78, 3072
    s_add_u32 s95, s86, 3145728
    buffer_load_dwordx4 v23, s[16:19], s95 offen sc1 lds
    s_add_u32 m0, s78, 4096
    s_add_u32 s95, s86, 3178496
    buffer_load_dwordx4 v20, s[16:19], s95 offen sc1 lds
    s_add_u32 m0, s78, 5120
    s_add_u32 s95, s86, 3178496
    buffer_load_dwordx4 v21, s[16:19], s95 offen sc1 lds
    s_add_u32 m0, s78, 6144
    s_add_u32 s95, s86, 3178496
    buffer_load_dwordx4 v22, s[16:19], s95 offen sc1 lds
    s_add_u32 m0, s78, 7168
    s_add_u32 s95, s86, 3178496
    buffer_load_dwordx4 v23, s[16:19], s95 offen sc1 lds
    s_add_u32 s49, s49, 1
    s_waitcnt vmcnt(0)
L_t0f:
    ds_read_b128 v[8:11], v26 offset:0
    ds_read_b128 v[12:15], v26 offset:1024
    s_waitcnt lgkmcnt(0)
    v_max_u32 v27, v8, v9
    v_max3_u32 v27, v27, v10, v11
    v_max3_u32 v27, v27, v12, v13
    v_max3_u32 v27, v27, v14, v15
    ds_read_b128 v[8:11], v26 offset:2048
    ds_read_b128 v[12:15], v26 offset:3072
    s_waitcnt lgkmcnt(0)
    v_max3_u32 v27, v27, v8, v9
    v_max3_u32 v27, v27, v10, v11
    v_max3_u32 v27, v27, v12, v13
    v_max3_u32 v27, v27, v14, v15
    ds_read_b128 v[8:11], v26 offset:4096
    ds_read_b128 v[12:15], v26 offset:5120
    s_waitcnt lgkmcnt(0)
    v_max3_u32 v27, v27, v8, v9
    v_max3_u32 v27, v27, v10, v11
    v_max3_u32 v27, v27, v12, v13
    v_max3_u32 v27, v27, v14, v15
    ds_read_b128 v[8:11], v26 offset:6144
    ds_read_b128 v[12:15], v26 offset:7168
    s_waitcnt lgkmcnt(0)
    v_max3_u32 v27, v27, v8, v9
    v_max3_u32 v27, v27, v10, v11
    v_max3_u32 v27, v27, v12, v13
    v_max3_u32 v27, v27, v14, v15
    v_cmp_eq_u32 vcc, -1, v27
    s_cmp_ge_u32 s49, 8192
    s_cbranch_scc1 L_t0g
    s_cbranch_vccnz L_t0r
L_t0g:
    ds_read_b128 v[8:11], v4 offset:0
    ds_read_b128 v[12:15], v4 offset:4096
    ds_read_b128 v[32:35], v5 offset:0
    ds_read_b128 v[164:167], v5 offset:4096
    s_waitcnt lgkmcnt(2)
    v_mfma_f32_32x32x16_bf16 v[36:51], v[100:103], v[8:11], v[36:51]
    v_mfma_f32_32x32x16_bf16 v[52:67], v[100:103], v[12:15], v[52:67]
    v_mfma_f32_32x32x16_bf16 v[68:83], v[104:107], v[8:11], v[68:83]
    v_mfma_f32_32x32x16_bf16 v[84:99], v[104:107], v[12:15], v[84:99]
    ds_read_b128 v[8:11], v6 offset:0
    ds_read_b128 v[12:15], v6 offset:4096
    s_waitcnt lgkmcnt(2)
    v_mfma_f32_32x32x16_bf16 v[36:51], v[108:111], v[32:35], v[36:51]
    v_mfma_f32_32x32x16_bf16 v[52:67], v[108:111], v[164:167], v[52:67]
    v_mfma_f32_32x32x16_bf16 v[68:83], v[112:115], v[32:35], v[68:83]
    v_mfma_f32_32x32x16_bf16 v[84:99], v[112:115], v[164:167], v[84:99]
    ds_read_b128 v[32:35], v7 offset:0
    ds_read_b128 v[164:167], v7 offset:4096
    s_waitcnt lgkmcnt(2)
    v_mfma_f32_32x32x16_bf16 v[36:51], v[116:119], v[8:11], v[36:51]
    v_mfma_f32_32x32x16_bf16 v[52:67], v[116:119], v[12:15], v[52:67]
    v_mfma_f32_32x32x16_bf16 v[68:83], v[120:123], v[8:11], v[68:83]
    v_mfma_f32_32x32x16_bf16 v[84:99], v[120:123], v[12:15], v[84:99]
    s_waitcnt lgkmcnt(0)
    v_mfma_f32_32x32x16_bf16 v[36:51], v[124:127], v[32:35], v[36:51]
    v_mfma_f32_32x32x16_bf16 v[52:67], v[124:127], v[164:167], v[52:67]
    v_mfma_f32_32x32x16_bf16 v[68:83], v[128:131], v[32:35], v[68:83]
    v_mfma_f32_32x32x16_bf16 v[84:99], v[128:131], v[164:167], v[84:99]
    s_mov_b32 s49, 0
    s_waitcnt vmcnt(0)
    s_branch L_t1f
L_t1r:
    s_sleep 4
    s_add_u32 m0, s78, 8192
    s_add_u32 s95, s86, 3145856
    buffer_load_dwordx4 v20, s[16:19], s95 offen sc1 lds
    s_add_u32 m0, s78, 9216
    s_add_u32 s95, s86, 3145856
    buffer_load_dwordx4 v21, s[16:19], s95 offen sc1 lds
    s_add_u32 m0, s78, 10240
    s_add_u32 s95, s86, 3145856
    buffer_load_dwordx4 v22, s[16:19], s95 offen sc1 lds
    s_add_u32 m0, s78, 11264
    s_add_u32 s95, s86, 3145856
    buffer_load_dwordx4 v23, s[16:19], s95 offen sc1 lds
    s_add_u32 m0, s78, 12288
    s_add_u32 s95, s86, 3178624
    buffer_load_dwordx4 v20, s[16:19], s95 offen sc1 lds
    s_add_u32 m0, s78, 13312
    s_add_u32 s95, s86, 3178624
    buffer_load_dwordx4 v21, s[16:19], s95 offen sc1 lds
    s_add_u32 m0, s78, 14336
    s_add_u32 s95, s86, 3178624
    buffer_load_dwordx4 v22, s[16:19], s95 offen sc1 lds
    s_add_u32 m0, s78, 15360
    s_add_u32 s95, s86, 3178624
    buffer_load_dwordx4 v23, s[16:19], s95 offen sc1 lds
    s_add_u32 s49, s49, 1
    s_waitcnt vmcnt(0)
L_t1f:
    ds_read_b128 v[8:11], v26 offset:8192
    ds_read_b128 v[12:15], v26 offset:9216
    s_waitcnt lgkmcnt(0)
    v_max_u32 v27, v8, v9
    v_max3_u32 v27, v27, v10, v11
    v_max3_u32 v27, v27, v12, v13
    v_max3_u32 v27, v27, v14, v15
    ds_read_b128 v[8:11], v26 offset:10240
    ds_read_b128 v[12:15], v26 offset:11264
    s_waitcnt lgkmcnt(0)
    v_max3_u32 v27, v27, v8, v9
    v_max3_u32 v27, v27, v10, v11
    v_max3_u32 v27, v27, v12, v13
    v_max3_u32 v27, v27, v14, v15
    ds_read_b128 v[8:11], v26 offset:12288
    ds_read_b128 v[12:15], v26 offset:13312
    s_waitcnt lgkmcnt(0)
    v_max3_u32 v27, v27, v8, v9
    v_max3_u32 v27, v27, v10, v11
    v_max3_u32 v27, v27, v12, v13
    v_max3_u32 v27, v27, v14, v15
    ds_read_b128 v[8:11], v26 offset:14336
    ds_read_b128 v[12:15], v26 offset:15360
    s_waitcnt lgkmcnt(0)
    v_max3_u32 v27, v27, v8, v9
    v_max3_u32 v27, v27, v10, v11
    v_max3_u32 v27, v27, v12, v13
    v_max3_u32 v27, v27, v14, v15
    v_cmp_eq_u32 vcc, -1, v27
    s_cmp_ge_u32 s49, 8192
    s_cbranch_scc1 L_t1g
    s_cbranch_vccnz L_t1r
L_t1g:
    ds_read_b128 v[8:11], v4 offset:8192
    ds_read_b128 v[12:15], v4 offset:12288
    ds_read_b128 v[32:35], v5 offset:8192
    ds_read_b128 v[164:167], v5 offset:12288
    s_waitcnt lgkmcnt(2)
    v_mfma_f32_32x32x16_bf16 v[36:51], v[132:135], v[8:11], v[36:51]
    v_mfma_f32_32x32x16_bf16 v[52:67], v[132:135], v[12:15], v[52:67]
    v_mfma_f32_32x32x16_bf16 v[68:83], v[136:139], v[8:11], v[68:83]
    v_mfma_f32_32x32x16_bf16 v[84:99], v[136:139], v[12:15], v[84:99]
    ds_read_b128 v[8:11], v6 offset:8192
    ds_read_b128 v[12:15], v6 offset:12288
    s_waitcnt lgkmcnt(2)
    v_mfma_f32_32x32x16_bf16 v[36:51], v[140:143], v[32:35], v[36:51]
    v_mfma_f32_32x32x16_bf16 v[52:67], v[140:143], v[164:167], v[52:67]
    v_mfma_f32_32x32x16_bf16 v[68:83], v[144:147], v[32:35], v[68:83]
    v_mfma_f32_32x32x16_bf16 v[84:99], v[144:147], v[164:167], v[84:99]
    ds_read_b128 v[32:35], v7 offset:8192
    ds_read_b128 v[164:167], v7 offset:12288
    s_waitcnt lgkmcnt(2)
    v_mfma_f32_32x32x16_bf16 v[36:51], v[148:151], v[8:11], v[36:51]
    v_mfma_f32_32x32x16_bf16 v[52:67], v[148:151], v[12:15], v[52:67]
    v_mfma_f32_32x32x16_bf16 v[68:83], v[152:155], v[8:11], v[68:83]
    v_mfma_f32_32x32x16_bf16 v[84:99], v[152:155], v[12:15], v[84:99]
    s_waitcnt lgkmcnt(0)
    v_mfma_f32_32x32x16_bf16 v[36:51], v[156:159], v[32:35], v[36:51]
    v_mfma_f32_32x32x16_bf16 v[52:67], v[156:159], v[164:167], v[52:67]
    v_mfma_f32_32x32x16_bf16 v[68:83], v[160:163], v[32:35], v[68:83]
    v_mfma_f32_32x32x16_bf16 v[84:99], v[160:163], v[164:167], v[84:99]
    s_nop 11
    s_nop 0
    s_cmp_eq_u32 s90, 0
    s_cbranch_scc1 L_rw0
    s_sub_u32 s48, s90, 1
    s_and_b32 s48, s48, 3
    s_add_u32 s48, s48, 0
    s_lshl_b32 s48, s48, 12
    s_add_u32 s48, s48, 0
    v_add_u32 v8, s48, v16
    ds_write_b128 v8, v[36:39] offset:0
    ds_write_b128 v8, v[40:43] offset:1024
    ds_write_b128 v8, v[44:47] offset:2048
    ds_write_b128 v8, v[48:51] offset:3072
L_rw0:
    s_cmp_eq_u32 s90, 1
    s_cbranch_scc1 L_rw1
    s_sub_u32 s48, s90, 2
    s_and_b32 s48, s48, 3
    s_add_u32 s48, s48, 3
    s_lshl_b32 s48, s48, 12
    s_add_u32 s48, s48, 0
    v_add_u32 v8, s48, v16
    ds_write_b128 v8, v[52:55] offset:0
    ds_write_b128 v8, v[56:59] offset:1024
    ds_write_b128 v8, v[60:63] offset:2048
    ds_write_b128 v8, v[64:67] offset:3072
L_rw1:
    s_cmp_eq_u32 s90, 2
    s_cbranch_scc1 L_rw2
    s_sub_u32 s48, s90, 3
    s_and_b32 s48, s48, 3
    s_add_u32 s48, s48, 6
    s_lshl_b32 s48, s48, 12
    s_add_u32 s48, s48, 0
    v_add_u32 v8, s48, v16
    ds_write_b128 v8, v[68:71] offset:0
    ds_write_b128 v8, v[72:75] offset:1024
    ds_write_b128 v8, v[76:79] offset:2048
    ds_write_b128 v8, v[80:83] offset:3072
L_rw2:
    s_cmp_eq_u32 s90, 3
    s_cbranch_scc1 L_rw3
    s_sub_u32 s48, s90, 4
    s_and_b32 s48, s48, 3
    s_add_u32 s48, s48, 9
    s_lshl_b32 s48, s48, 12
    s_add_u32 s48, s48, 0
    v_add_u32 v8, s48, v16
    ds_write_b128 v8, v[84:87] offset:0
    ds_write_b128 v8, v[88:91] offset:1024
    ds_write_b128 v8, v[92:95] offset:2048
    ds_write_b128 v8, v[96:99] offset:3072
L_rw3:
    s_mul_i32 s48, s90, 12288
    s_add_u32 s48, s48, 0
    v_add_u32 v8, s48, v16
    s_and_b32 s48, s90, 1
    s_lshl_b32 s48, s48, 5
    s_add_u32 s48, s48, s6
    v_add_u32 v9, s48, v19
    v_lshlrev_b32 v9, 10, v9
    v_lshrrev_b32 v10, 5, v1
    v_lshlrev_b32 v10, 4, v10
    v_add_u32 v9, v9, v10
    s_lshl_b32 s85, s5, 7
    s_lshr_b32 s49, s90, 1
    s_lshl_b32 s49, s49, 6
    s_add_u32 s85, s85, s49
    s_waitcnt lgkmcnt(0)
    s_barrier
    ds_read_b128 v[100:103], v8 offset:0
    ds_read_b128 v[104:107], v8 offset:1024
    ds_read_b128 v[108:111], v8 offset:2048
    ds_read_b128 v[112:115], v8 offset:3072
    ds_read_b128 v[116:119], v8 offset:4096
    ds_read_b128 v[120:123], v8 offset:5120
    ds_read_b128 v[124:127], v8 offset:6144
    ds_read_b128 v[128:131], v8 offset:7168
    ds_read_b128 v[132:135], v8 offset:8192
    ds_read_b128 v[136:139], v8 offset:9216
    ds_read_b128 v[140:143], v8 offset:10240
    ds_read_b128 v[144:147], v8 offset:11264
    s_cmp_lg_u32 s90, 0
    s_cbranch_scc1 L_ow0
    v_mov_b32 v148, v36
    v_mov_b32 v149, v37
    v_mov_b32 v150, v38
    v_mov_b32 v151, v39
    v_mov_b32 v152, v40
    v_mov_b32 v153, v41
    v_mov_b32 v154, v42
    v_mov_b32 v155, v43
    v_mov_b32 v156, v44
    v_mov_b32 v157, v45
    v_mov_b32 v158, v46
    v_mov_b32 v159, v47
    v_mov_b32 v160, v48
    v_mov_b32 v161, v49
    v_mov_b32 v162, v50
    v_mov_b32 v163, v51
L_ow0:
    s_cmp_lg_u32 s90, 1
    s_cbranch_scc1 L_ow1
    v_mov_b32 v148, v52
    v_mov_b32 v149, v53
    v_mov_b32 v150, v54
    v_mov_b32 v151, v55
    v_mov_b32 v152, v56
    v_mov_b32 v153, v57
    v_mov_b32 v154, v58
    v_mov_b32 v155, v59
    v_mov_b32 v156, v60
    v_mov_b32 v157, v61
    v_mov_b32 v158, v62
    v_mov_b32 v159, v63
    v_mov_b32 v160, v64
    v_mov_b32 v161, v65
    v_mov_b32 v162, v66
    v_mov_b32 v163, v67
L_ow1:
    s_cmp_lg_u32 s90, 2
    s_cbranch_scc1 L_ow2
    v_mov_b32 v148, v68
    v_mov_b32 v149, v69
    v_mov_b32 v150, v70
    v_mov_b32 v151, v71
    v_mov_b32 v152, v72
    v_mov_b32 v153, v73
    v_mov_b32 v154, v74
    v_mov_b32 v155, v75
    v_mov_b32 v156, v76
    v_mov_b32 v157, v77
    v_mov_b32 v158, v78
    v_mov_b32 v159, v79
    v_mov_b32 v160, v80
    v_mov_b32 v161, v81
    v_mov_b32 v162, v82
    v_mov_b32 v163, v83
L_ow2:
    s_cmp_lg_u32 s90, 3
    s_cbranch_scc1 L_ow3
    v_mov_b32 v148, v84
    v_mov_b32 v149, v85
    v_mov_b32 v150, v86
    v_mov_b32 v151, v87
    v_mov_b32 v152, v88
    v_mov_b32 v153, v89
    v_mov_b32 v154, v90
    v_mov_b32 v155, v91
    v_mov_b32 v156, v92
    v_mov_b32 v157, v93
    v_mov_b32 v158, v94
    v_mov_b32 v159, v95
    v_mov_b32 v160, v96
    v_mov_b32 v161, v97
    v_mov_b32 v162, v98
    v_mov_b32 v163, v99
L_ow3:
    s_waitcnt lgkmcnt(0)
    v_add_f32 v100, v100, v116
    v_add_f32 v132, v132, v148
    v_add_f32 v101, v101, v117
    v_add_f32 v133, v133, v149
    v_add_f32 v102, v102, v118
    v_add_f32 v134, v134, v150
    v_add_f32 v103, v103, v119
    v_add_f32 v135, v135, v151
    v_add_f32 v104, v104, v120
    v_add_f32 v136, v136, v152
    v_add_f32 v105, v105, v121
    v_add_f32 v137, v137, v153
    v_add_f32 v106, v106, v122
    v_add_f32 v138, v138, v154
    v_add_f32 v107, v107, v123
    v_add_f32 v139, v139, v155
    v_add_f32 v108, v108, v124
    v_add_f32 v140, v140, v156
    v_add_f32 v109, v109, v125
    v_add_f32 v141, v141, v157
    v_add_f32 v110, v110, v126
    v_add_f32 v142, v142, v158
    v_add_f32 v111, v111, v127
    v_add_f32 v143, v143, v159
    v_add_f32 v112, v112, v128
    v_add_f32 v144, v144, v160
    v_add_f32 v113, v113, v129
    v_add_f32 v145, v145, v161
    v_add_f32 v114, v114, v130
    v_add_f32 v146, v146, v162
    v_add_f32 v115, v115, v131
    v_add_f32 v147, v147, v163
    v_add_f32 v100, v100, v132
    v_add_f32 v101, v101, v133
    v_add_f32 v102, v102, v134
    v_add_f32 v103, v103, v135
    v_add_f32 v104, v104, v136
    v_add_f32 v105, v105, v137
    v_add_f32 v106, v106, v138
    v_add_f32 v107, v107, v139
    v_add_f32 v108, v108, v140
    v_add_f32 v109, v109, v141
    v_add_f32 v110, v110, v142
    v_add_f32 v111, v111, v143
    v_add_f32 v112, v112, v144
    v_add_f32 v113, v113, v145
    v_add_f32 v114, v114, v146
    v_add_f32 v115, v115, v147
    v_cvt_pk_bf16_f32 v48, v100, v101
    v_cvt_pk_bf16_f32 v49, v102, v103
    v_cvt_pk_bf16_f32 v50, v104, v105
    v_cvt_pk_bf16_f32 v51, v106, v107
    v_cvt_pk_bf16_f32 v52, v108, v109
    v_cvt_pk_bf16_f32 v53, v110, v111
    v_cvt_pk_bf16_f32 v54, v112, v113
    v_cvt_pk_bf16_f32 v55, v114, v115
    v_permlane32_swap_b32 v48, v50
    v_permlane32_swap_b32 v49, v51
    v_permlane32_swap_b32 v52, v54
    v_permlane32_swap_b32 v53, v55
    buffer_store_dwordx4 v[48:51], v9, s[40:43], s85 offen
    buffer_store_dwordx4 v[52:55], v9, s[40:43], s85 offen offset:32
L_end:
    s_endpgm
.section .rodata,"a"
.p2align 6
.amdhsa_kernel gated_mix__sliding_local_dilated__grouped_kv_mqa__prompt_kernel
  .amdhsa_next_free_vgpr 168
  .amdhsa_next_free_sgpr 102
  .amdhsa_accum_offset 168
  .amdhsa_group_segment_fixed_size 0
  .amdhsa_kernarg_size 96
  .amdhsa_user_sgpr_count 2
  .amdhsa_user_sgpr_kernarg_segment_ptr 1
  .amdhsa_system_sgpr_workgroup_id_x 1
.end_amdhsa_kernel
```
